```python
import torch

def _softmax(x, axis=-1):
    return torch.softmax(x, dim=axis)

def _gelu(x):
    return torch.nn.functional.gelu(x, approximate='tanh')

def _silu(x):
    return torch.nn.functional.silu(x)

def _sigmoid(x):
    return torch.sigmoid(x)

def _layernorm(x, axis=-1, eps=1e-05):
    m = x.mean(dim=axis, keepdim=True)
    v = x.var(dim=axis, keepdim=True, unbiased=False)
    return (x - m) / torch.sqrt(v + eps)

def _scatter_add(tgt, idx, src, axis=0):
    return tgt.clone().index_add_(axis, idx, src)

def _segment_sum(src, seg, n):
    out = torch.zeros((n,) + src.shape[1:], dtype=src.dtype)
    return out.index_add_(0, seg, src)

def _pad(x, pw):
    flat = tuple((v for pair in reversed(pw) for v in pair))
    return torch.nn.functional.pad(x, flat)
kernel_name = 'adaLN_cond__gqa_block_cached__dense_activation_relu__decode'

def setup_inputs():

    _w = lambda a: (lambda t: t.to(torch.bfloat16) if t.is_floating_point() else t)(torch.as_tensor(a))

    def _A_setup():
        B, Sq, D = (8, 1, 512)
        Hq, Hkv, Sk, Dh = (32, 8, 4096, 128)
        assert Hq % Hkv == 0, (Hq, Hkv)
        return {'x': _w((lambda *s: torch.randn(*s, dtype=torch.bfloat16) * 0.1)(B, Sq, D)), 'k_cache': _w((lambda *s: torch.randn(*s, dtype=torch.bfloat16) * 0.8)(B, Hkv, Sk, Dh)), 'v_cache': _w((lambda *s: torch.randn(*s, dtype=torch.bfloat16) * 0.8)(B, Hkv, Sk, Dh)), 'wq': _w((lambda *s: torch.randn(*s, dtype=torch.bfloat16) * 0.8)(D, Hq * Dh) * D ** (-0.5)), 'wo': _w((lambda *s: torch.randn(*s, dtype=torch.bfloat16) * 0.8)(Hq * Dh, D) * (Hq * Dh) ** (-0.5))}
    _A_in = _A_setup()

    def _B_setup():
        B, S, D, Dff = (8, 1, 512, 1792)
        return {'x': _w((lambda *s: torch.randn(*s, dtype=torch.bfloat16) * 0.1)(B, S, D)), 'w1': _w((lambda *s: torch.randn(*s, dtype=torch.bfloat16) * 0.1)(D, Dff)), 'w2': _w((lambda *s: torch.randn(*s, dtype=torch.bfloat16) * 0.1)(Dff, D))}
    _B_in = _B_setup()
    return {'A_x': _A_in['x'], 'A_k_cache': _A_in['k_cache'], 'A_v_cache': _A_in['v_cache'], 'A_wq': _A_in['wq'], 'A_wo': _A_in['wo'], 'B_x': _B_in['x'], 'B_w1': _B_in['w1'], 'B_w2': _B_in['w2'], 'c': _w((lambda *s: torch.randn(*s, dtype=torch.bfloat16) * 0.8)(8, 512) * 8.0), 'w_mod': _w((lambda *s: torch.randn(*s, dtype=torch.bfloat16) * 0.8)(512, 6 * 512) * 512 ** (-0.5) * 8.0)}

def reference(A_x, A_k_cache, A_v_cache, A_wq, A_wo, B_x, B_w1, B_w2, c, w_mod):

    def _A_ref(x, k_cache, v_cache, wq, wo):
        B, Sq, D = x.shape
        Hq, Dh = (32, 128)
        Hkv = k_cache.shape[1]
        rep = Hq // Hkv
        q = (lambda x, *d: x.permute(*d))((x @ wq).reshape(B, Sq, Hq, Dh), 0, 2, 1, 3)
        k = (lambda x, n, axis: torch.repeat_interleave(x, n, dim=axis))(k_cache, rep, axis=1)
        v = (lambda x, n, axis: torch.repeat_interleave(x, n, dim=axis))(v_cache, rep, axis=1)
        scores = torch.einsum('bhqd,bhkd->bhqk', q, k) * Dh ** (-0.5)
        p = _softmax(scores, axis=-1)
        o = torch.einsum('bhqk,bhkd->bhqd', p, v)
        return (lambda x, *d: x.permute(*d))(o, 0, 2, 1, 3).reshape(B, Sq, Hq * Dh) @ wo

    def _B_ref(x, w1, w2):
        h = torch.einsum('bsd,df->bsf', x, w1)
        zero = torch.zeros_like(h)
        h = torch.maximum(h, zero)
        return torch.einsum('bsf,fd->bsd', h, w2)
    x = A_x
    mod = (_silu(c) @ w_mod).reshape(c.shape[0], 6, 1, -1)
    sa, ca, ga, sb, cb, gb = (mod[:, 0].clone(), mod[:, 1].clone(), mod[:, 2].clone(), mod[:, 3].clone(), mod[:, 4].clone(), mod[:, 5].clone())
    h = _layernorm(x, axis=-1) * (1 + ca) + sa
    x = x + ga * _A_ref(h, A_k_cache, A_v_cache, A_wq, A_wo)
    h = _layernorm(x, axis=-1) * (1 + cb) + sb
    x = x + gb * _B_ref(h, B_w1, B_w2)
    return x
```

```asm
; @launch grid=(256,1,1) block=(512,1,1) lds=163840
.amdgcn_target "amdgcn-amd-amdhsa--gfx950"
.text
.globl adaLN_cond__gqa_block_cached__dense_activation_relu__decode_kernel
.p2align 8
.type adaLN_cond__gqa_block_cached__dense_activation_relu__decode_kernel,@function
adaLN_cond__gqa_block_cached__dense_activation_relu__decode_kernel:
    s_cmp_ge_u32 s2, 256
    s_cbranch_scc1 L_end
    s_load_dwordx16 s[4:19], s[0:1], 0
    s_load_dwordx8 s[20:27], s[0:1], 64
    s_load_dwordx2 s[28:29], s[0:1], 96
    v_lshrrev_b32 v1, 6, v0
    v_and_b32 v0, 63, v0
    v_readfirstlane_b32 s84, v1
    s_and_b32 s80, s2, 7
    s_lshr_b32 s81, s2, 5
    s_bfe_u32 s82, s2, 0x20003
    v_lshlrev_b32 v2, 10, v1
    v_lshl_add_u32 v2, v0, 4, v2
    v_lshlrev_b32 v1, 10, v1
    v_and_b32 v3, 3, v0
    v_lshl_add_u32 v1, v3, 4, v1
    v_bfe_u32 v4, v0, 2, 2
    v_lshl_add_u32 v1, v4, 8, v1
    v_lshrrev_b32 v4, 4, v0
    v_lshl_add_u32 v1, v4, 6, v1
    s_lshl_b32 s95, s81, 23
    s_lshl_b32 s96, s80, 20
    s_add_u32 s95, s95, s96
    s_lshl_b32 s96, s82, 18
    s_add_u32 s95, s95, s96
    s_waitcnt lgkmcnt(0)
    s_add_u32 s32, s6, s95
    s_addc_u32 s33, s7, 0
    s_mov_b32 s34, 262144
    s_mov_b32 s35, 0x20000
    buffer_load_dwordx4 v[48:51], v1, s[32:35], 0 offen offset:0 nt
    s_mov_b32 s90, 8192
    buffer_load_dwordx4 v[52:55], v1, s[32:35], s90 offen offset:0 nt
    s_mov_b32 s90, 16384
    buffer_load_dwordx4 v[56:59], v1, s[32:35], s90 offen offset:0 nt
    s_mov_b32 s90, 24576
    buffer_load_dwordx4 v[60:63], v1, s[32:35], s90 offen offset:0 nt
    s_load_dword s99, s[28:29], 0
    s_add_u32 s36, s8, s95
    s_addc_u32 s37, s9, 0
    s_mov_b32 s38, 262144
    s_mov_b32 s39, 0x20000
    s_lshl_b32 s98, s80, 2
    s_add_u32 s98, s98, s82
    s_mov_b32 s95, 0x18020100
    s_cmp_eq_u32 s80, 1
    s_cselect_b32 s95, 0x18050403, s95
    s_cmp_eq_u32 s80, 2
    s_cselect_b32 s95, 0x19080607, s95
    s_cmp_eq_u32 s80, 3
    s_cselect_b32 s95, 0x190a090b, s95
    s_cmp_eq_u32 s80, 4
    s_cselect_b32 s95, 0x1a0e0d1b, s95
    s_cmp_eq_u32 s80, 5
    s_cselect_b32 s95, 0x1a11100f, s95
    s_cmp_eq_u32 s80, 6
    s_cselect_b32 s95, 0xc141213, s95
    s_cmp_eq_u32 s80, 7
    s_cselect_b32 s95, 0xc161517, s95
    s_lshl_b32 s96, s82, 3
    s_lshr_b32 s101, s95, s96
    s_and_b32 s101, s101, 0xff
    s_mov_b32 s95, s101
    s_xor_b32 s96, s80, s81
    s_and_b32 s96, s96, 1
    s_cselect_b32 s95, 28, s95
    s_lshl_b32 s96, s96, 1
    s_lshl_b32 s3, s80, 3
    s_add_u32 s3, s3, s81
    s_lshr_b32 s97, s3, 1
    s_add_u32 s3, s3, 32
    s_mov_b32 s83, 1
    s_cmp_eq_u32 s82, 3
    s_cselect_b32 s101, s95, s101
    s_cselect_b32 s3, s97, s3
    s_cselect_b32 s83, s96, s83
    s_cmp_lt_u32 s82, 2
    s_cselect_b32 s83, 3, s83
    s_mov_b32 s92, 0x05040100
    s_mov_b32 s93, 0x07060302
    s_mov_b32 s94, 1069066811
    v_and_b32 v31, 15, v0
    v_lshrrev_b32 v25, 4, v0
    s_lshl_b32 s96, s84, 3
    v_add_u32 v26, s96, v25
    s_lshl_b32 s100, s84, 14
    s_add_u32 s100, s100, 32768
    v_lshrrev_b32 v27, 5, v0
    v_lshlrev_b32 v27, 1, v27
    v_xor_b32 v27, v27, v0
    v_and_b32 v27, 3, v27
    s_lshl_b32 s96, s84, 6
    v_lshrrev_b32 v24, 2, v0
    v_add_u32 v24, s96, v24
    s_mov_b32 s60, s20
    s_mov_b32 s61, s21
    s_mov_b32 s62, 8192
    s_mov_b32 s63, 0x20000
    s_mov_b32 s56, s4
    s_mov_b32 s57, s5
    s_mov_b32 s58, 8192
    s_mov_b32 s59, 0x20000
    s_cmp_lt_u32 s83, 2
    s_cselect_b32 s64, s22, s10
    s_cselect_b32 s65, s23, s11
    s_mov_b32 s66, 0x400000
    s_cselect_b32 s66, 0x300000, s66
    s_mov_b32 s67, 0x20000
    s_cmp_ge_u32 s83, 2
    s_cbranch_scc1 L_s_q
    s_lshl_b32 s95, s3, 6
    v_lshlrev_b32 v4, 4, v27
    v_mul_u32_u24 v3, 6144, v24
    v_add3_u32 v3, v3, v4, s95
    v_lshrrev_b32 v27, 3, v31
    v_and_b32 v4, 7, v0
    v_lshlrev_b32 v4, 10, v4
    v_lshl_add_u32 v4, v27, 6, v4
    v_lshl_add_u32 v4, v25, 4, v4
    s_lshl_b32 s95, s84, 7
    buffer_load_dwordx4 v[248:251], v4, s[60:63], s95 offen
    s_add_u32 m0, s100, 8192
    s_mov_b32 s90, 0
    buffer_load_dwordx4 v3, s[64:67], s90 offen  lds
    s_add_u32 m0, s100, 9216
    s_mov_b32 s90, 98304
    buffer_load_dwordx4 v3, s[64:67], s90 offen  lds
    s_add_u32 m0, s100, 10240
    s_mov_b32 s90, 196608
    buffer_load_dwordx4 v3, s[64:67], s90 offen  lds
    s_add_u32 m0, s100, 11264
    s_mov_b32 s90, 294912
    buffer_load_dwordx4 v3, s[64:67], s90 offen  lds
    s_mov_b32 s40, s28
    s_mov_b32 s41, s29
    s_mov_b32 s42, 2621440
    s_mov_b32 s43, 0x20000
    s_mov_b32 s68, s24
    s_mov_b32 s69, s25
    s_mov_b32 s70, 8192
    s_mov_b32 s71, 0x20000
    s_lshl_b32 s95, s80, 19
    s_lshl_b32 s96, s82, 8
    s_add_u32 s95, s95, s96
    s_and_b32 s96, s81, 1
    s_lshl_b32 s96, s96, 7
    s_add_u32 s95, s95, s96
    s_sub_u32 s96, 0x400000, s95
    s_add_u32 s44, s12, s95
    s_addc_u32 s45, s13, 0
    s_mov_b32 s46, s96
    s_mov_b32 s47, 0x20000
    s_lshl_b32 s95, s101, 7
    s_sub_u32 s96, 0x1c0000, s95
    s_cmp_lt_u32 s101, 28
    s_cselect_b32 s96, s96, 0
    s_cselect_b32 s95, s95, 0
    s_add_u32 s48, s16, s95
    s_addc_u32 s49, s17, 0
    s_mov_b32 s50, s96
    s_mov_b32 s51, 0x20000
    s_lshl_b32 s95, s101, 16
    s_cmp_lt_u32 s101, 28
    s_cselect_b32 s96, 0x10000, 0
    s_cselect_b32 s95, s95, 0
    s_add_u32 s52, s18, s95
    s_addc_u32 s53, s19, 0
    s_mov_b32 s54, s96
    s_mov_b32 s55, 0x20000
    v_bfe_u32 v5, v0, 4, 1
    v_lshlrev_b32 v5, 1, v5
    v_xor_b32 v5, v5, v0
    v_and_b32 v5, 7, v5
    v_lshlrev_b32 v5, 4, v5
    s_lshl_b32 s95, s84, 6
    v_lshrrev_b32 v6, 3, v0
    v_add_u32 v6, s95, v6
    v_lshl_add_u32 v29, v6, 10, v5
    v_xor_b32 v30, 64, v29
    v_mul_u32_u24 v6, 3584, v6
    v_add_u32 v5, v5, v6
    v_xor_b32 v6, 64, v5
    v_lshlrev_b32 v4, 4, v0
    v_add_u32 v4, s100, v4
    v_mov_b32 v7, 0xffffff00
    v_and_b32 v28, 1, v0
    v_lshlrev_b32 v28, 4, v28
    v_and_b32 v24, 2, v0
    v_cmp_eq_u32 vcc, 0, v24
    v_mov_b32 v24, 3340
    v_lshlrev_b32 v24, v28, v24
    v_cndmask_b32 v8, 0, v24, vcc
    v_cndmask_b32 v9, v24, 0, vcc
    v_xor_b32 v8, 0x0c0c0c0c, v8
    v_xor_b32 v9, 0x0c0c0c0c, v9
    v_mov_b32 v24, 3854
    v_lshlrev_b32 v24, v28, v24
    v_cndmask_b32 v10, 0, v24, vcc
    v_cndmask_b32 v11, v24, 0, vcc
    v_xor_b32 v10, 0x0c0c0c0c, v10
    v_xor_b32 v11, 0x0c0c0c0c, v11
    v_mov_b32 v12, 0
    v_mov_b32 v13, 0
    v_mov_b32 v14, 0
    v_mov_b32 v15, 0
    ds_write_b128 v12, v[12:15] offset:1024
    s_waitcnt lgkmcnt(0)
    s_barrier
    v_lshrrev_b32 v242, 4, v0
    v_lshlrev_b32 v240, 9, v242
    v_and_b32 v242, 1, v242
    v_lshl_add_u32 v240, v242, 5, v240
    v_bfe_u32 v242, v0, 2, 2
    v_lshl_add_u32 v240, v242, 6, v240
    v_and_b32 v242, 3, v0
    v_lshl_add_u32 v240, v242, 3, v240
    v_add_u32 v240, s100, v240
    v_xor_b32 v241, 32, v240
    s_waitcnt vmcnt(4)
    v_lshlrev_b32 v192, 16, v248
    v_and_b32 v193, 0xffff0000, v248
    v_lshlrev_b32 v194, 16, v249
    v_and_b32 v195, 0xffff0000, v249
    v_lshlrev_b32 v196, 16, v250
    v_and_b32 v197, 0xffff0000, v250
    v_lshlrev_b32 v198, 16, v251
    v_and_b32 v199, 0xffff0000, v251
    v_mul_f32 v200, 0xbfb8aa3b, v192
    v_mul_f32 v201, 0xbfb8aa3b, v193
    v_mul_f32 v202, 0xbfb8aa3b, v194
    v_mul_f32 v203, 0xbfb8aa3b, v195
    v_mul_f32 v204, 0xbfb8aa3b, v196
    v_mul_f32 v205, 0xbfb8aa3b, v197
    v_mul_f32 v206, 0xbfb8aa3b, v198
    v_mul_f32 v207, 0xbfb8aa3b, v199
    v_min_f32 v200, 0x42fc0000, v200
    v_min_f32 v201, 0x42fc0000, v201
    v_min_f32 v202, 0x42fc0000, v202
    v_min_f32 v203, 0x42fc0000, v203
    v_min_f32 v204, 0x42fc0000, v204
    v_min_f32 v205, 0x42fc0000, v205
    v_min_f32 v206, 0x42fc0000, v206
    v_min_f32 v207, 0x42fc0000, v207
    v_exp_f32 v200, v200
    v_exp_f32 v201, v201
    v_exp_f32 v202, v202
    v_exp_f32 v203, v203
    v_exp_f32 v204, v204
    v_exp_f32 v205, v205
    v_exp_f32 v206, v206
    v_exp_f32 v207, v207
    v_add_f32 v200, 1.0, v200
    v_add_f32 v201, 1.0, v201
    v_add_f32 v202, 1.0, v202
    v_add_f32 v203, 1.0, v203
    v_add_f32 v204, 1.0, v204
    v_add_f32 v205, 1.0, v205
    v_add_f32 v206, 1.0, v206
    v_add_f32 v207, 1.0, v207
    v_rcp_f32 v208, v200
    v_rcp_f32 v209, v201
    v_rcp_f32 v210, v202
    v_rcp_f32 v211, v203
    v_mul_f32 v248, v192, v208
    v_mul_f32 v249, v193, v209
    v_mul_f32 v250, v194, v210
    v_mul_f32 v251, v195, v211
    v_fma_f32 v192, -v248, v200, v192
    v_fma_f32 v193, -v249, v201, v193
    v_fma_f32 v194, -v250, v202, v194
    v_fma_f32 v195, -v251, v203, v195
    v_fma_f32 v192, v192, v208, v248
    v_fma_f32 v193, v193, v209, v249
    v_fma_f32 v194, v194, v210, v250
    v_fma_f32 v195, v195, v211, v251
    v_rcp_f32 v208, v204
    v_rcp_f32 v209, v205
    v_rcp_f32 v210, v206
    v_rcp_f32 v211, v207
    v_mul_f32 v248, v196, v208
    v_mul_f32 v249, v197, v209
    v_mul_f32 v250, v198, v210
    v_mul_f32 v251, v199, v211
    v_fma_f32 v196, -v248, v204, v196
    v_fma_f32 v197, -v249, v205, v197
    v_fma_f32 v198, -v250, v206, v198
    v_fma_f32 v199, -v251, v207, v199
    v_fma_f32 v196, v196, v208, v248
    v_fma_f32 v197, v197, v209, v249
    v_fma_f32 v198, v198, v210, v250
    v_fma_f32 v199, v199, v211, v251
    v_cvt_pk_bf16_f32 v248, v192, v193
    v_cvt_pk_bf16_f32 v249, v194, v195
    v_cvt_pk_bf16_f32 v250, v196, v197
    v_cvt_pk_bf16_f32 v251, v198, v199
    v_mov_b32_dpp v244, v248 row_ror:8 row_mask:0xf bank_mask:0xf
    v_mov_b32_dpp v245, v249 row_ror:8 row_mask:0xf bank_mask:0xf
    v_mov_b32_dpp v246, v250 row_ror:8 row_mask:0xf bank_mask:0xf
    v_mov_b32_dpp v247, v251 row_ror:8 row_mask:0xf bank_mask:0xf
    s_waitcnt vmcnt(0)
    ds_read_b64_tr_b16 v[176:177], v240 offset:8192
    ds_read_b64_tr_b16 v[178:179], v240 offset:8448
    ds_read_b64_tr_b16 v[180:181], v241 offset:8192
    ds_read_b64_tr_b16 v[182:183], v241 offset:8448
    ds_read_b64_tr_b16 v[184:185], v240 offset:10240
    ds_read_b64_tr_b16 v[186:187], v240 offset:10496
    ds_read_b64_tr_b16 v[188:189], v241 offset:10240
    ds_read_b64_tr_b16 v[190:191], v241 offset:10496
    s_waitcnt lgkmcnt(0)
    v_mfma_f32_16x16x32_bf16 v[16:19], v[176:179], v[248:251], 0
    v_mfma_f32_16x16x32_bf16 v[20:23], v[180:183], v[248:251], 0
    v_mfma_f32_16x16x32_bf16 v[16:19], v[184:187], v[244:247], v[16:19]
    v_mfma_f32_16x16x32_bf16 v[20:23], v[188:191], v[244:247], v[20:23]
    s_nop 6
    ds_write_b128 v4, v[16:19] offset:12288
    ds_write_b128 v4, v[20:23] offset:13312
    s_branch L_s_done
L_s_q:
    s_cmp_ge_u32 s83, 3
    s_cbranch_scc1 L_s_idle
    v_lshrrev_b32 v27, 3, v31
    v_and_b32 v4, 7, v0
    v_lshlrev_b32 v4, 10, v4
    v_lshl_add_u32 v4, v27, 6, v4
    v_lshl_add_u32 v4, v25, 4, v4
    s_lshl_b32 s95, s84, 7
    v_lshlrev_b32 v244, 4, v0
    s_lshl_b32 s96, s84, 10
    buffer_load_dwordx4 v[252:255], v244, s[56:59], s96 offen
    buffer_load_dwordx4 v[248:251], v4, s[56:59], s95 offen
    s_lshl_b32 s95, s84, 6
    v_add_u32 v3, s95, v25
    v_lshlrev_b32 v3, 13, v3
    v_lshlrev_b32 v27, 1, v25
    v_xor_b32 v27, v27, v31
    v_lshl_add_u32 v3, v27, 4, v3
    s_lshl_b32 s95, s3, 8
    v_add_u32 v3, s95, v3
    v_xor_b32 v4, 128, v3
    s_add_u32 m0, s100, 0
    s_mov_b32 s90, 0
    buffer_load_dwordx4 v3, s[64:67], s90 offen  lds
    s_add_u32 m0, s100, 1024
    s_mov_b32 s90, 32768
    buffer_load_dwordx4 v3, s[64:67], s90 offen  lds
    s_add_u32 m0, s100, 2048
    s_mov_b32 s90, 65536
    buffer_load_dwordx4 v4, s[64:67], s90 offen  lds
    s_add_u32 m0, s100, 3072
    s_mov_b32 s90, 98304
    buffer_load_dwordx4 v4, s[64:67], s90 offen  lds
    s_add_u32 m0, s100, 4096
    s_mov_b32 s90, 131072
    buffer_load_dwordx4 v3, s[64:67], s90 offen  lds
    s_add_u32 m0, s100, 5120
    s_mov_b32 s90, 163840
    buffer_load_dwordx4 v3, s[64:67], s90 offen  lds
    s_add_u32 m0, s100, 6144
    s_mov_b32 s90, 196608
    buffer_load_dwordx4 v4, s[64:67], s90 offen  lds
    s_add_u32 m0, s100, 7168
    s_mov_b32 s90, 229376
    buffer_load_dwordx4 v4, s[64:67], s90 offen  lds
    s_add_u32 m0, s100, 8192
    s_mov_b32 s90, 262144
    buffer_load_dwordx4 v3, s[64:67], s90 offen  lds
    s_add_u32 m0, s100, 9216
    s_mov_b32 s90, 294912
    buffer_load_dwordx4 v3, s[64:67], s90 offen  lds
    s_add_u32 m0, s100, 10240
    s_mov_b32 s90, 327680
    buffer_load_dwordx4 v4, s[64:67], s90 offen  lds
    s_add_u32 m0, s100, 11264
    s_mov_b32 s90, 360448
    buffer_load_dwordx4 v4, s[64:67], s90 offen  lds
    s_add_u32 m0, s100, 12288
    s_mov_b32 s90, 393216
    buffer_load_dwordx4 v3, s[64:67], s90 offen  lds
    s_add_u32 m0, s100, 13312
    s_mov_b32 s90, 425984
    buffer_load_dwordx4 v3, s[64:67], s90 offen  lds
    s_add_u32 m0, s100, 14336
    s_mov_b32 s90, 458752
    buffer_load_dwordx4 v4, s[64:67], s90 offen  lds
    s_add_u32 m0, s100, 15360
    s_mov_b32 s90, 491520
    buffer_load_dwordx4 v4, s[64:67], s90 offen  lds
    s_mov_b32 s90, 32768
    buffer_load_dwordx4 v[64:67], v1, s[32:35], s90 offen offset:0 nt
    s_mov_b32 s90, 40960
    buffer_load_dwordx4 v[68:71], v1, s[32:35], s90 offen offset:0 nt
    s_mov_b32 s90, 49152
    buffer_load_dwordx4 v[72:75], v1, s[32:35], s90 offen offset:0 nt
    s_mov_b32 s90, 57344
    buffer_load_dwordx4 v[76:79], v1, s[32:35], s90 offen offset:0 nt
    s_mov_b32 s40, s28
    s_mov_b32 s41, s29
    s_mov_b32 s42, 2621440
    s_mov_b32 s43, 0x20000
    s_mov_b32 s68, s24
    s_mov_b32 s69, s25
    s_mov_b32 s70, 8192
    s_mov_b32 s71, 0x20000
    s_lshl_b32 s95, s80, 19
    s_lshl_b32 s96, s82, 8
    s_add_u32 s95, s95, s96
    s_and_b32 s96, s81, 1
    s_lshl_b32 s96, s96, 7
    s_add_u32 s95, s95, s96
    s_sub_u32 s96, 0x400000, s95
    s_add_u32 s44, s12, s95
    s_addc_u32 s45, s13, 0
    s_mov_b32 s46, s96
    s_mov_b32 s47, 0x20000
    s_lshl_b32 s95, s101, 7
    s_sub_u32 s96, 0x1c0000, s95
    s_cmp_lt_u32 s101, 28
    s_cselect_b32 s96, s96, 0
    s_cselect_b32 s95, s95, 0
    s_add_u32 s48, s16, s95
    s_addc_u32 s49, s17, 0
    s_mov_b32 s50, s96
    s_mov_b32 s51, 0x20000
    s_lshl_b32 s95, s101, 16
    s_cmp_lt_u32 s101, 28
    s_cselect_b32 s96, 0x10000, 0
    s_cselect_b32 s95, s95, 0
    s_add_u32 s52, s18, s95
    s_addc_u32 s53, s19, 0
    s_mov_b32 s54, s96
    s_mov_b32 s55, 0x20000
    v_bfe_u32 v5, v0, 4, 1
    v_lshlrev_b32 v5, 1, v5
    v_xor_b32 v5, v5, v0
    v_and_b32 v5, 7, v5
    v_lshlrev_b32 v5, 4, v5
    s_lshl_b32 s95, s84, 6
    v_lshrrev_b32 v6, 3, v0
    v_add_u32 v6, s95, v6
    v_lshl_add_u32 v29, v6, 10, v5
    v_xor_b32 v30, 64, v29
    v_mul_u32_u24 v6, 3584, v6
    v_add_u32 v5, v5, v6
    v_xor_b32 v6, 64, v5
    v_lshlrev_b32 v4, 4, v0
    v_add_u32 v4, s100, v4
    v_mov_b32 v7, 0xffffff00
    v_and_b32 v28, 1, v0
    v_lshlrev_b32 v28, 4, v28
    v_and_b32 v24, 2, v0
    v_cmp_eq_u32 vcc, 0, v24
    v_mov_b32 v24, 3340
    v_lshlrev_b32 v24, v28, v24
    v_cndmask_b32 v8, 0, v24, vcc
    v_cndmask_b32 v9, v24, 0, vcc
    v_xor_b32 v8, 0x0c0c0c0c, v8
    v_xor_b32 v9, 0x0c0c0c0c, v9
    v_mov_b32 v24, 3854
    v_lshlrev_b32 v24, v28, v24
    v_cndmask_b32 v10, 0, v24, vcc
    v_cndmask_b32 v11, v24, 0, vcc
    v_xor_b32 v10, 0x0c0c0c0c, v10
    v_xor_b32 v11, 0x0c0c0c0c, v11
    v_mov_b32 v12, 0
    v_mov_b32 v13, 0
    v_mov_b32 v14, 0
    v_mov_b32 v15, 0
    ds_write_b128 v12, v[12:15] offset:1024
    s_waitcnt lgkmcnt(0)
    s_barrier
    s_add_u32 s99, s99, 1
    s_mul_i32 s89, s99, 0x9e3779b1
    s_lshr_b32 s95, s89, 15
    s_xor_b32 s89, s89, s95
    s_mul_i32 s89, s89, 0x85ebca77
    s_lshr_b32 s95, s89, 13
    s_xor_b32 s89, s89, s95
    s_and_b32 s85, s89, 0xff
    s_bfe_u32 s86, s89, 0x80008
    s_bfe_u32 s87, s89, 0x80010
    s_lshr_b32 s88, s89, 24
    s_waitcnt vmcnt(20)
    v_lshlrev_b32 v192, 16, v252
    v_and_b32 v193, 0xffff0000, v252
    v_lshlrev_b32 v194, 16, v253
    v_and_b32 v195, 0xffff0000, v253
    v_lshlrev_b32 v196, 16, v254
    v_and_b32 v197, 0xffff0000, v254
    v_lshlrev_b32 v198, 16, v255
    v_and_b32 v199, 0xffff0000, v255
    v_add_f32 v208, v192, v193
    v_add_f32 v208, v208, v194
    v_add_f32 v208, v208, v195
    v_add_f32 v208, v208, v196
    v_add_f32 v208, v208, v197
    v_add_f32 v208, v208, v198
    v_add_f32 v208, v208, v199
    s_nop 1
    v_add_f32_dpp v208, v208, v208 row_ror:8 row_mask:0xf bank_mask:0xf
    s_nop 1
    v_add_f32_dpp v208, v208, v208 row_ror:4 row_mask:0xf bank_mask:0xf
    s_nop 1
    v_add_f32_dpp v208, v208, v208 row_ror:2 row_mask:0xf bank_mask:0xf
    s_nop 1
    v_add_f32_dpp v208, v208, v208 row_ror:1 row_mask:0xf bank_mask:0xf
    v_mov_b32 v210, v208
    s_nop 1
    v_permlane16_swap_b32 v210, v208
    v_add_f32 v208, v208, v210
    v_mov_b32 v210, v208
    s_nop 1
    v_permlane32_swap_b32 v210, v208
    v_add_f32 v208, v208, v210
    v_mul_f32 v208, 0x3b000000, v208
    v_sub_f32 v200, v192, v208
    v_sub_f32 v201, v193, v208
    v_sub_f32 v202, v194, v208
    v_sub_f32 v203, v195, v208
    v_sub_f32 v204, v196, v208
    v_sub_f32 v205, v197, v208
    v_sub_f32 v206, v198, v208
    v_sub_f32 v207, v199, v208
    v_mul_f32 v209, v200, v200
    v_fmac_f32 v209, v201, v201
    v_fmac_f32 v209, v202, v202
    v_fmac_f32 v209, v203, v203
    v_fmac_f32 v209, v204, v204
    v_fmac_f32 v209, v205, v205
    v_fmac_f32 v209, v206, v206
    v_fmac_f32 v209, v207, v207
    s_nop 1
    v_add_f32_dpp v209, v209, v209 row_ror:8 row_mask:0xf bank_mask:0xf
    s_nop 1
    v_add_f32_dpp v209, v209, v209 row_ror:4 row_mask:0xf bank_mask:0xf
    s_nop 1
    v_add_f32_dpp v209, v209, v209 row_ror:2 row_mask:0xf bank_mask:0xf
    s_nop 1
    v_add_f32_dpp v209, v209, v209 row_ror:1 row_mask:0xf bank_mask:0xf
    v_mov_b32 v210, v209
    s_nop 1
    v_permlane16_swap_b32 v210, v209
    v_add_f32 v209, v209, v210
    v_mov_b32 v210, v209
    s_nop 1
    v_permlane32_swap_b32 v210, v209
    v_add_f32 v209, v209, v210
    v_mul_f32 v209, 0x3b000000, v209
    v_cvt_pk_bf16_f32 v208, 0, v208
    v_cvt_pk_bf16_f32 v209, 0, v209
    v_add_f32 v209, 925353388, v209
    v_cvt_pk_bf16_f32 v209, 0, v209
    v_sqrt_f32 v209, v209
    s_nop 0
    v_cvt_pk_bf16_f32 v209, 0, v209
    v_rcp_f32 v209, v209
    s_lshl_b32 s95, s84, 3
    v_mov_b32 v210, s95
    s_mov_b64 exec, 1
    ds_write_b64 v210, v[208:209] offset:19968
    s_mov_b64 exec, -1
    v_lshrrev_b32 v213, 4, v0
    v_bfe_u32 v214, v0, 2, 2
    v_lshl_add_u32 v212, v213, 3, v214
    v_lshlrev_b32 v212, 8, v212
    v_and_b32 v213, 1, v213
    v_lshl_add_u32 v213, v213, 2, v214
    v_xor_b32 v213, s84, v213
    v_lshl_add_u32 v212, v213, 5, v212
    v_and_b32 v213, 3, v0
    v_lshl_add_u32 v212, v213, 3, v212
    v_add_u32 v212, 32768, v212
    v_add_u32 v213, 0x10000, v212
    v_and_b32 v214, 7, v0
    v_lshlrev_b32 v215, 3, v214
    s_waitcnt vmcnt(4)
    s_waitcnt lgkmcnt(0)
    s_barrier
    ds_read_b64 v[216:217], v215 offset:19968
    ds_read_b64_tr_b16 v[128:129], v212 offset:0
    ds_read_b64_tr_b16 v[130:131], v212 offset:1024
    ds_read_b64_tr_b16 v[132:133], v212 offset:8192
    ds_read_b64_tr_b16 v[134:135], v212 offset:9216
    ds_read_b64_tr_b16 v[136:137], v212 offset:16384
    ds_read_b64_tr_b16 v[138:139], v212 offset:17408
    ds_read_b64_tr_b16 v[140:141], v212 offset:24576
    ds_read_b64_tr_b16 v[142:143], v212 offset:25600
    s_waitcnt lgkmcnt(6)
    ds_read_b64_tr_b16 v[144:145], v212 offset:32768
    ds_read_b64_tr_b16 v[146:147], v212 offset:33792
    ds_read_b64_tr_b16 v[148:149], v212 offset:40960
    ds_read_b64_tr_b16 v[150:151], v212 offset:41984
    ds_read_b64_tr_b16 v[152:153], v212 offset:49152
    ds_read_b64_tr_b16 v[154:155], v212 offset:50176
    ds_read_b64_tr_b16 v[156:157], v212 offset:57344
    ds_read_b64_tr_b16 v[158:159], v212 offset:58368
    s_waitcnt lgkmcnt(6)
    ds_read_b64_tr_b16 v[160:161], v213 offset:0
    ds_read_b64_tr_b16 v[162:163], v213 offset:1024
    ds_read_b64_tr_b16 v[164:165], v213 offset:8192
    ds_read_b64_tr_b16 v[166:167], v213 offset:9216
    ds_read_b64_tr_b16 v[168:169], v213 offset:16384
    ds_read_b64_tr_b16 v[170:171], v213 offset:17408
    ds_read_b64_tr_b16 v[172:173], v213 offset:24576
    ds_read_b64_tr_b16 v[174:175], v213 offset:25600
    s_waitcnt lgkmcnt(6)
    ds_read_b64_tr_b16 v[176:177], v213 offset:32768
    ds_read_b64_tr_b16 v[178:179], v213 offset:33792
    ds_read_b64_tr_b16 v[180:181], v213 offset:40960
    ds_read_b64_tr_b16 v[182:183], v213 offset:41984
    ds_read_b64_tr_b16 v[184:185], v213 offset:49152
    ds_read_b64_tr_b16 v[186:187], v213 offset:50176
    ds_read_b64_tr_b16 v[188:189], v213 offset:57344
    ds_read_b64_tr_b16 v[190:191], v213 offset:58368
    s_waitcnt lgkmcnt(6)
    s_setprio 2
    s_mov_b32 s90, 65536
    buffer_load_dwordx4 v[80:83], v1, s[32:35], s90 offen offset:0 nt
    s_mov_b32 s90, 73728
    buffer_load_dwordx4 v[84:87], v1, s[32:35], s90 offen offset:0 nt
    s_mov_b32 s90, 81920
    buffer_load_dwordx4 v[88:91], v1, s[32:35], s90 offen offset:0 nt
    s_mov_b32 s90, 90112
    buffer_load_dwordx4 v[92:95], v1, s[32:35], s90 offen offset:0 nt
    v_lshlrev_b32 v192, 16, v248
    v_and_b32 v193, 0xffff0000, v248
    v_lshlrev_b32 v194, 16, v249
    v_and_b32 v195, 0xffff0000, v249
    v_lshlrev_b32 v196, 16, v250
    v_and_b32 v197, 0xffff0000, v250
    v_lshlrev_b32 v198, 16, v251
    v_and_b32 v199, 0xffff0000, v251
    v_sub_f32 v192, v192, v216
    v_sub_f32 v193, v193, v216
    v_sub_f32 v194, v194, v216
    v_sub_f32 v195, v195, v216
    v_sub_f32 v196, v196, v216
    v_sub_f32 v197, v197, v216
    v_sub_f32 v198, v198, v216
    v_sub_f32 v199, v199, v216
    v_cvt_pk_bf16_f32 v192, 0, v192
    v_cvt_pk_bf16_f32 v193, 0, v193
    v_cvt_pk_bf16_f32 v194, 0, v194
    v_cvt_pk_bf16_f32 v195, 0, v195
    v_cvt_pk_bf16_f32 v196, 0, v196
    v_cvt_pk_bf16_f32 v197, 0, v197
    v_cvt_pk_bf16_f32 v198, 0, v198
    v_cvt_pk_bf16_f32 v199, 0, v199
    v_mul_f32 v192, v192, v217
    v_mul_f32 v193, v193, v217
    v_mul_f32 v194, v194, v217
    v_mul_f32 v195, v195, v217
    v_mul_f32 v196, v196, v217
    v_mul_f32 v197, v197, v217
    v_mul_f32 v198, v198, v217
    v_mul_f32 v199, v199, v217
    v_cvt_pk_bf16_f32 v192, 0, v192
    v_cvt_pk_bf16_f32 v193, 0, v193
    v_cvt_pk_bf16_f32 v194, 0, v194
    v_cvt_pk_bf16_f32 v195, 0, v195
    v_cvt_pk_bf16_f32 v196, 0, v196
    v_cvt_pk_bf16_f32 v197, 0, v197
    v_cvt_pk_bf16_f32 v198, 0, v198
    v_cvt_pk_bf16_f32 v199, 0, v199
    s_lshl_b32 s95, s84, 11
    s_add_u32 s95, s95, 1572864
    v_lshlrev_b32 v4, 4, v0
    v_add_u32 v3, s95, v4
    v_and_b32 v24, 0x370, v4
    s_lshl_b32 s95, s84, 10
    v_add_u32 v4, s95, v4
    s_lshl_b32 s95, s84, 5
    v_lshlrev_b32 v28, 9, v214
    v_bfe_u32 v31, v0, 4, 1
    v_lshl_add_u32 v28, v31, 8, v28
    v_lshrrev_b32 v31, 5, v0
    v_lshl_add_u32 v28, v31, 4, v28
    v_add_u32 v28, s95, v28
    s_lshl_b32 s95, s3, 9
    s_add_u32 s95, s95, 131072
    v_lshlrev_b32 v26, 14, v31
    v_and_b32 v31, 31, v0
    v_lshl_add_u32 v26, v31, 4, v26
    v_add_u32 v26, s95, v26
    v_lshlrev_b32 v27, 4, v0
    s_waitcnt lgkmcnt(0)
    s_mov_b32 s91, 400015
L_poll_1:
    buffer_load_dwordx4 v[224:227], v3, s[40:43], 0 offen offset:0 sc1
    buffer_load_dwordx4 v[228:231], v3, s[40:43], 0 offen offset:1024 sc1
    s_mov_b32 s90, 16384
    buffer_load_dwordx4 v[232:235], v3, s[40:43], s90 offen offset:0 sc1
    s_mov_b32 s90, 16384
    buffer_load_dwordx4 v[236:239], v3, s[40:43], s90 offen offset:1024 sc1
    s_waitcnt vmcnt(0)
    v_xor_b32 v224, s85, v224
    v_xor_b32 v225, s86, v225
    v_xor_b32 v226, s87, v226
    v_xor_b32 v227, s88, v227
    v_or3_b32 v31, v224, v225, v226
    v_or_b32 v31, v31, v227
    v_xor_b32 v228, s85, v228
    v_xor_b32 v229, s86, v229
    v_xor_b32 v230, s87, v230
    v_xor_b32 v231, s88, v231
    v_or3_b32 v31, v31, v228, v229
    v_or3_b32 v31, v31, v230, v231
    v_xor_b32 v232, s85, v232
    v_xor_b32 v233, s86, v233
    v_xor_b32 v234, s87, v234
    v_xor_b32 v235, s88, v235
    v_or3_b32 v31, v31, v232, v233
    v_or3_b32 v31, v31, v234, v235
    v_xor_b32 v236, s85, v236
    v_xor_b32 v237, s86, v237
    v_xor_b32 v238, s87, v238
    v_xor_b32 v239, s88, v239
    v_or3_b32 v31, v31, v236, v237
    v_or3_b32 v31, v31, v238, v239
    v_and_b32 v31, 0xff, v31
    v_cmp_ne_u32 vcc, 0, v31
    s_cbranch_vccz L_done_2
    s_sleep 8
    s_sub_u32 s91, s91, 1
    s_cbranch_scc0 L_poll_1
L_done_2:
    s_mov_b32 s90, 98304
    buffer_load_dwordx4 v[96:99], v1, s[32:35], s90 offen offset:0 nt
    v_add_f32 v232, 1.0, v232
    v_add_f32 v233, 1.0, v233
    v_add_f32 v234, 1.0, v234
    v_add_f32 v235, 1.0, v235
    v_add_f32 v236, 1.0, v236
    v_add_f32 v237, 1.0, v237
    v_add_f32 v238, 1.0, v238
    v_add_f32 v239, 1.0, v239
    v_cvt_pk_bf16_f32 v232, 0, v232
    v_cvt_pk_bf16_f32 v233, 0, v233
    v_cvt_pk_bf16_f32 v234, 0, v234
    v_cvt_pk_bf16_f32 v235, 0, v235
    v_cvt_pk_bf16_f32 v236, 0, v236
    v_cvt_pk_bf16_f32 v237, 0, v237
    v_cvt_pk_bf16_f32 v238, 0, v238
    v_cvt_pk_bf16_f32 v239, 0, v239
    v_mul_f32 v192, v192, v232
    v_mul_f32 v193, v193, v233
    v_mul_f32 v194, v194, v234
    v_mul_f32 v195, v195, v235
    v_mul_f32 v196, v196, v236
    v_mul_f32 v197, v197, v237
    v_mul_f32 v198, v198, v238
    v_mul_f32 v199, v199, v239
    v_cvt_pk_bf16_f32 v192, 0, v192
    v_cvt_pk_bf16_f32 v193, 0, v193
    v_cvt_pk_bf16_f32 v194, 0, v194
    v_cvt_pk_bf16_f32 v195, 0, v195
    v_cvt_pk_bf16_f32 v196, 0, v196
    v_cvt_pk_bf16_f32 v197, 0, v197
    v_cvt_pk_bf16_f32 v198, 0, v198
    v_cvt_pk_bf16_f32 v199, 0, v199
    v_add_f32 v192, v192, v224
    v_add_f32 v193, v193, v225
    v_add_f32 v194, v194, v226
    v_add_f32 v195, v195, v227
    v_add_f32 v196, v196, v228
    v_add_f32 v197, v197, v229
    v_add_f32 v198, v198, v230
    v_add_f32 v199, v199, v231
    v_cvt_pk_bf16_f32 v224, v192, v193
    v_cvt_pk_bf16_f32 v225, v194, v195
    v_cvt_pk_bf16_f32 v226, v196, v197
    v_cvt_pk_bf16_f32 v227, v198, v199
    ds_write_b128 v4, v[224:227] offset:11776
    s_waitcnt lgkmcnt(0)
    s_barrier
    ds_read_b128 v[192:195], v24 offset:11776
    ds_read_b128 v[196:199], v24 offset:11904
    ds_read_b128 v[200:203], v24 offset:12800
    ds_read_b128 v[204:207], v24 offset:12928
    ds_read_b128 v[208:211], v24 offset:13824
    ds_read_b128 v[212:215], v24 offset:13952
    ds_read_b128 v[216:219], v24 offset:14848
    ds_read_b128 v[220:223], v24 offset:14976
    ds_read_b128 v[224:227], v24 offset:15872
    s_waitcnt lgkmcnt(8)
    v_mfma_f32_16x16x32_bf16 v[16:19], v[128:131], v[192:195], 0
    ds_read_b128 v[228:231], v24 offset:16000
    s_waitcnt lgkmcnt(8)
    v_mfma_f32_16x16x32_bf16 v[16:19], v[132:135], v[196:199], v[16:19]
    ds_read_b128 v[232:235], v24 offset:16896
    s_waitcnt lgkmcnt(8)
    v_mfma_f32_16x16x32_bf16 v[16:19], v[136:139], v[200:203], v[16:19]
    ds_read_b128 v[236:239], v24 offset:17024
    s_waitcnt lgkmcnt(8)
    v_mfma_f32_16x16x32_bf16 v[16:19], v[140:143], v[204:207], v[16:19]
    ds_read_b128 v[240:243], v24 offset:17920
    s_waitcnt lgkmcnt(8)
    v_mfma_f32_16x16x32_bf16 v[16:19], v[144:147], v[208:211], v[16:19]
    ds_read_b128 v[244:247], v24 offset:18048
    s_waitcnt lgkmcnt(8)
    v_mfma_f32_16x16x32_bf16 v[16:19], v[148:151], v[212:215], v[16:19]
    ds_read_b128 v[248:251], v24 offset:18944
    s_waitcnt lgkmcnt(8)
    v_mfma_f32_16x16x32_bf16 v[16:19], v[152:155], v[216:219], v[16:19]
    ds_read_b128 v[252:255], v24 offset:19072
    s_waitcnt lgkmcnt(8)
    v_mfma_f32_16x16x32_bf16 v[16:19], v[156:159], v[220:223], v[16:19]
    s_waitcnt lgkmcnt(7)
    v_mfma_f32_16x16x32_bf16 v[16:19], v[160:163], v[224:227], v[16:19]
    s_waitcnt lgkmcnt(6)
    v_mfma_f32_16x16x32_bf16 v[16:19], v[164:167], v[228:231], v[16:19]
    s_waitcnt lgkmcnt(5)
    v_mfma_f32_16x16x32_bf16 v[16:19], v[168:171], v[232:235], v[16:19]
    s_waitcnt lgkmcnt(4)
    v_mfma_f32_16x16x32_bf16 v[16:19], v[172:175], v[236:239], v[16:19]
    s_waitcnt lgkmcnt(3)
    v_mfma_f32_16x16x32_bf16 v[16:19], v[176:179], v[240:243], v[16:19]
    s_waitcnt lgkmcnt(2)
    v_mfma_f32_16x16x32_bf16 v[16:19], v[180:183], v[244:247], v[16:19]
    s_waitcnt lgkmcnt(1)
    v_mfma_f32_16x16x32_bf16 v[16:19], v[184:187], v[248:251], v[16:19]
    s_waitcnt lgkmcnt(0)
    v_mfma_f32_16x16x32_bf16 v[16:19], v[188:191], v[252:255], v[16:19]
    s_nop 7
    v_cvt_pk_bf16_f32 v16, 0, v16
    v_cvt_pk_bf16_f32 v17, 0, v17
    v_cvt_pk_bf16_f32 v18, 0, v18
    v_cvt_pk_bf16_f32 v19, 0, v19
    v_or_b32 v16, s85, v16
    v_or_b32 v17, s86, v17
    v_or_b32 v18, s87, v18
    v_or_b32 v19, s88, v19
    s_mov_b32 exec_lo, 0x00ff00ff
    s_mov_b32 exec_hi, 0x00ff00ff
    ds_write_b128 v28, v[16:19] offset:20480
    s_mov_b64 exec, -1
    v_mov_b32 v13, 1
    ds_write_b32 v12, v13 offset:1036
    s_waitcnt lgkmcnt(0)
    s_barrier
    s_cmp_lg_u32 s84, 7
    s_cbranch_scc1 L_q_done
    ds_read_b128 v[192:195], v27 offset:20480
    ds_read_b128 v[196:199], v27 offset:21504
    ds_read_b128 v[200:203], v27 offset:22528
    ds_read_b128 v[204:207], v27 offset:23552
    s_waitcnt lgkmcnt(3)
    s_mov_b32 s90, 0
    buffer_store_dwordx4 v[192:195], v26, s[40:43], s90 offen
    s_waitcnt lgkmcnt(2)
    s_mov_b32 s90, 32768
    buffer_store_dwordx4 v[196:199], v26, s[40:43], s90 offen
    s_waitcnt lgkmcnt(1)
    s_mov_b32 s90, 65536
    buffer_store_dwordx4 v[200:203], v26, s[40:43], s90 offen
    s_waitcnt lgkmcnt(0)
    s_mov_b32 s90, 98304
    buffer_store_dwordx4 v[204:207], v26, s[40:43], s90 offen
L_q_done:
    s_add_u32 m0, s100, 0
    s_mov_b32 s90, 0
    buffer_load_dwordx4 v29, s[44:47], s90 offen  lds
    s_add_u32 m0, s100, 1024
    s_mov_b32 s90, 8192
    buffer_load_dwordx4 v30, s[44:47], s90 offen  lds
    s_add_u32 m0, s100, 2048
    s_mov_b32 s90, 16384
    buffer_load_dwordx4 v29, s[44:47], s90 offen  lds
    s_add_u32 m0, s100, 3072
    s_mov_b32 s90, 24576
    buffer_load_dwordx4 v30, s[44:47], s90 offen  lds
    s_add_u32 m0, s100, 4096
    s_mov_b32 s90, 32768
    buffer_load_dwordx4 v29, s[44:47], s90 offen  lds
    s_add_u32 m0, s100, 5120
    s_mov_b32 s90, 40960
    buffer_load_dwordx4 v30, s[44:47], s90 offen  lds
    s_mov_b32 s60, 2
    s_cmp_eq_u32 s84, 0
    s_cbranch_scc1 L_aux_late
    s_branch L_stream_13
L_s_idle:
    s_mov_b32 s60, s22
    s_mov_b32 s61, s23
    s_mov_b32 s62, 3145728
    s_mov_b32 s63, 0x20000
    s_lshl_b32 s95, s81, 4
    s_lshl_b32 s96, s82, 3
    s_add_u32 s95, s95, s96
    s_add_u32 s95, s95, s84
    s_mul_i32 s96, s95, 24576
    s_lshl_b32 s97, s80, 8
    s_add_u32 s96, s96, s97
    v_mul_u32_u24 v3, 6144, v25
    v_lshl_add_u32 v3, v31, 4, v3
    buffer_load_dwordx4 v[68:71], v3, s[60:63], s96 offen
    s_lshl_b32 s95, s95, 15
    s_lshl_b32 s97, s80, 10
    s_add_u32 s95, s95, s97
    v_lshlrev_b32 v3, 4, v0
    buffer_load_dwordx4 v[72:75], v3, s[64:67], s95 offen
    s_add_u32 s95, s95, 8192
    buffer_load_dwordx4 v[76:79], v3, s[64:67], s95 offen
    s_add_u32 s95, s95, 8192
    buffer_load_dwordx4 v[80:83], v3, s[64:67], s95 offen
    s_add_u32 s95, s95, 8192
    buffer_load_dwordx4 v[84:87], v3, s[64:67], s95 offen
    s_mov_b32 s40, s28
    s_mov_b32 s41, s29
    s_mov_b32 s42, 2621440
    s_mov_b32 s43, 0x20000
    s_mov_b32 s68, s24
    s_mov_b32 s69, s25
    s_mov_b32 s70, 8192
    s_mov_b32 s71, 0x20000
    s_lshl_b32 s95, s80, 19
    s_lshl_b32 s96, s82, 8
    s_add_u32 s95, s95, s96
    s_and_b32 s96, s81, 1
    s_lshl_b32 s96, s96, 7
    s_add_u32 s95, s95, s96
    s_sub_u32 s96, 0x400000, s95
    s_add_u32 s44, s12, s95
    s_addc_u32 s45, s13, 0
    s_mov_b32 s46, s96
    s_mov_b32 s47, 0x20000
    s_lshl_b32 s95, s101, 7
    s_sub_u32 s96, 0x1c0000, s95
    s_cmp_lt_u32 s101, 28
    s_cselect_b32 s96, s96, 0
    s_cselect_b32 s95, s95, 0
    s_add_u32 s48, s16, s95
    s_addc_u32 s49, s17, 0
    s_mov_b32 s50, s96
    s_mov_b32 s51, 0x20000
    s_lshl_b32 s95, s101, 16
    s_cmp_lt_u32 s101, 28
    s_cselect_b32 s96, 0x10000, 0
    s_cselect_b32 s95, s95, 0
    s_add_u32 s52, s18, s95
    s_addc_u32 s53, s19, 0
    s_mov_b32 s54, s96
    s_mov_b32 s55, 0x20000
    v_bfe_u32 v5, v0, 4, 1
    v_lshlrev_b32 v5, 1, v5
    v_xor_b32 v5, v5, v0
    v_and_b32 v5, 7, v5
    v_lshlrev_b32 v5, 4, v5
    s_lshl_b32 s95, s84, 6
    v_lshrrev_b32 v6, 3, v0
    v_add_u32 v6, s95, v6
    v_lshl_add_u32 v29, v6, 10, v5
    v_xor_b32 v30, 64, v29
    v_mul_u32_u24 v6, 3584, v6
    v_add_u32 v5, v5, v6
    v_xor_b32 v6, 64, v5
    v_lshlrev_b32 v4, 4, v0
    v_add_u32 v4, s100, v4
    v_mov_b32 v7, 0xffffff00
    v_and_b32 v28, 1, v0
    v_lshlrev_b32 v28, 4, v28
    v_and_b32 v24, 2, v0
    v_cmp_eq_u32 vcc, 0, v24
    v_mov_b32 v24, 3340
    v_lshlrev_b32 v24, v28, v24
    v_cndmask_b32 v8, 0, v24, vcc
    v_cndmask_b32 v9, v24, 0, vcc
    v_xor_b32 v8, 0x0c0c0c0c, v8
    v_xor_b32 v9, 0x0c0c0c0c, v9
    v_mov_b32 v24, 3854
    v_lshlrev_b32 v24, v28, v24
    v_cndmask_b32 v10, 0, v24, vcc
    v_cndmask_b32 v11, v24, 0, vcc
    v_xor_b32 v10, 0x0c0c0c0c, v10
    v_xor_b32 v11, 0x0c0c0c0c, v11
    v_mov_b32 v12, 0
    v_mov_b32 v13, 0
    v_mov_b32 v14, 0
    v_mov_b32 v15, 0
    ds_write_b128 v12, v[12:15] offset:1024
    s_waitcnt lgkmcnt(0)
    s_barrier
L_s_done:
    v_mov_b32 v13, 1
    s_waitcnt lgkmcnt(0)
    s_mov_b64 exec, 1
    ds_add_u32 v12, v13 offset:1028
    s_mov_b64 exec, -1
    s_add_u32 s99, s99, 1
    s_mul_i32 s89, s99, 0x9e3779b1
    s_lshr_b32 s95, s89, 15
    s_xor_b32 s89, s89, s95
    s_mul_i32 s89, s89, 0x85ebca77
    s_lshr_b32 s95, s89, 13
    s_xor_b32 s89, s89, s95
    s_and_b32 s85, s89, 0xff
    s_bfe_u32 s86, s89, 0x80008
    s_bfe_u32 s87, s89, 0x80010
    s_lshr_b32 s88, s89, 24
    s_mov_b32 s60, 0
    s_cmp_eq_u32 s83, 0
    s_cselect_b32 s97, 1, 0
    s_max_u32 s60, s60, s97
    s_and_b32 s95, s81, 1
    s_lshl_b32 s96, s82, 1
    s_add_u32 s95, s95, s96
    s_cmp_eq_u32 s95, 3
    s_cselect_b32 s97, 2, 0
    s_max_u32 s60, s60, s97
    s_and_b32 s95, s101, 3
    s_cmp_eq_u32 s95, 3
    s_cselect_b32 s97, 1, 0
    s_max_u32 s60, s60, s97
    s_and_b32 s95, s3, 14
    s_lshr_b32 s96, s83, 1
    s_lshl_b32 s96, s96, 4
    s_add_u32 s95, s95, s96
    s_cmp_eq_u32 s95, 6
    s_cselect_b32 s97, 1, 0
    s_max_u32 s60, s60, s97
    s_cmp_eq_u32 s84, 0
    s_cbranch_scc1 L_aux
L_stream:
    s_cmp_gt_u32 s60, 0
    s_cbranch_scc1 L_thr0_k4
    s_waitcnt vmcnt(7)
L_thr0_k4:
    s_cmp_gt_u32 s60, 1
    s_cbranch_scc1 L_thr1_k4
    s_waitcnt vmcnt(8)
L_thr1_k4:
    s_mov_b32 s90, 32768
    buffer_load_dwordx4 v[64:67], v1, s[32:35], s90 offen offset:0 nt
    s_add_u32 m0, s100, 0
    s_mov_b32 s90, 0
    buffer_load_dwordx4 v29, s[44:47], s90 offen  lds
    s_add_u32 m0, s100, 1024
    s_mov_b32 s90, 8192
    buffer_load_dwordx4 v30, s[44:47], s90 offen  lds
    s_cmp_gt_u32 s60, 0
    s_cbranch_scc1 L_thr0_k5
    s_waitcnt vmcnt(9)
L_thr0_k5:
    s_cmp_gt_u32 s60, 1
    s_cbranch_scc1 L_thr1_k5
    s_waitcnt vmcnt(10)
L_thr1_k5:
    s_mov_b32 s90, 40960
    buffer_load_dwordx4 v[68:71], v1, s[32:35], s90 offen offset:0 nt
    s_add_u32 m0, s100, 2048
    s_mov_b32 s90, 16384
    buffer_load_dwordx4 v29, s[44:47], s90 offen  lds
    s_cmp_gt_u32 s60, 0
    s_cbranch_scc1 L_thr0_k6
    s_waitcnt vmcnt(10)
L_thr0_k6:
    s_cmp_gt_u32 s60, 1
    s_cbranch_scc1 L_thr1_k6
    s_waitcnt vmcnt(11)
L_thr1_k6:
    s_mov_b32 s90, 49152
    buffer_load_dwordx4 v[72:75], v1, s[32:35], s90 offen offset:0 nt
    s_cmp_gt_u32 s60, 0
    s_cbranch_scc1 L_thr0_k7
    s_waitcnt vmcnt(5)
L_thr0_k7:
    s_cmp_gt_u32 s60, 1
    s_cbranch_scc1 L_thr1_k7
    s_waitcnt vmcnt(11)
L_thr1_k7:
    s_mov_b32 s90, 57344
    buffer_load_dwordx4 v[76:79], v1, s[32:35], s90 offen offset:0 nt
    s_add_u32 m0, s100, 3072
    s_mov_b32 s90, 24576
    buffer_load_dwordx4 v30, s[44:47], s90 offen  lds
    s_cmp_gt_u32 s60, 0
    s_cbranch_scc1 L_thr0_k8
    s_waitcnt vmcnt(4)
L_thr0_k8:
    s_cmp_gt_u32 s60, 1
    s_cbranch_scc1 L_thr1_k8
    s_waitcnt vmcnt(7)
L_thr1_k8:
    s_waitcnt vmcnt(16)
    s_setprio 2
    s_mov_b32 s90, 65536
    buffer_load_dwordx4 v[80:83], v1, s[32:35], s90 offen offset:0 nt
    s_cmp_gt_u32 s60, 0
    s_cbranch_scc1 L_thr0_k9
    s_waitcnt vmcnt(3)
L_thr0_k9:
    s_cmp_gt_u32 s60, 1
    s_cbranch_scc1 L_thr1_k9
    s_waitcnt vmcnt(5)
L_thr1_k9:
    s_waitcnt vmcnt(16)
    s_mov_b32 s90, 73728
    buffer_load_dwordx4 v[84:87], v1, s[32:35], s90 offen offset:0 nt
    s_add_u32 m0, s100, 4096
    s_mov_b32 s90, 32768
    buffer_load_dwordx4 v29, s[44:47], s90 offen  lds
    s_cmp_gt_u32 s60, 0
    s_cbranch_scc1 L_thr0_k10
    s_waitcnt vmcnt(4)
L_thr0_k10:
    s_cmp_gt_u32 s60, 1
    s_cbranch_scc1 L_thr1_k10
    s_waitcnt vmcnt(5)
L_thr1_k10:
    s_waitcnt vmcnt(17)
    s_mov_b32 s90, 81920
    buffer_load_dwordx4 v[88:91], v1, s[32:35], s90 offen offset:0 nt
    s_cmp_gt_u32 s60, 0
    s_cbranch_scc1 L_thr0_k11
    s_waitcnt vmcnt(3)
L_thr0_k11:
    s_cmp_gt_u32 s60, 1
    s_cbranch_scc1 L_thr1_k11
    s_waitcnt vmcnt(5)
L_thr1_k11:
    s_waitcnt vmcnt(17)
    s_mov_b32 s90, 90112
    buffer_load_dwordx4 v[92:95], v1, s[32:35], s90 offen offset:0 nt
    s_add_u32 m0, s100, 5120
    s_mov_b32 s90, 40960
    buffer_load_dwordx4 v30, s[44:47], s90 offen  lds
    s_cmp_gt_u32 s60, 0
    s_cbranch_scc1 L_thr0_k12
    s_waitcnt vmcnt(4)
L_thr0_k12:
    s_cmp_gt_u32 s60, 1
    s_cbranch_scc1 L_thr1_k12
    s_waitcnt vmcnt(5)
L_thr1_k12:
    s_waitcnt vmcnt(13)
    s_mov_b32 s90, 98304
    buffer_load_dwordx4 v[96:99], v1, s[32:35], s90 offen offset:0 nt
L_stream_13:
    s_cmp_gt_u32 s60, 0
    s_cbranch_scc1 L_thr0_k13
    s_waitcnt vmcnt(3)
L_thr0_k13:
    s_cmp_gt_u32 s60, 1
    s_cbranch_scc1 L_thr1_k13
    s_waitcnt vmcnt(5)
L_thr1_k13:
    s_mov_b32 s90, 106496
    buffer_load_dwordx4 v[100:103], v1, s[32:35], s90 offen offset:0 nt
    s_add_u32 m0, s100, 6144
    s_mov_b32 s90, 49152
    buffer_load_dwordx4 v29, s[44:47], s90 offen  lds
    s_cmp_gt_u32 s60, 0
    s_cbranch_scc1 L_thr0_k14
    s_waitcnt vmcnt(4)
L_thr0_k14:
    s_cmp_gt_u32 s60, 1
    s_cbranch_scc1 L_thr1_k14
    s_waitcnt vmcnt(5)
L_thr1_k14:
    s_mov_b32 s90, 114688
    buffer_load_dwordx4 v[104:107], v1, s[32:35], s90 offen offset:0 nt
    s_cmp_gt_u32 s60, 0
    s_cbranch_scc1 L_thr0_k15
    s_waitcnt vmcnt(3)
L_thr0_k15:
    s_cmp_gt_u32 s60, 1
    s_cbranch_scc1 L_thr1_k15
    s_waitcnt vmcnt(5)
L_thr1_k15:
    s_mov_b32 s90, 122880
    buffer_load_dwordx4 v[108:111], v1, s[32:35], s90 offen offset:0 nt
    s_add_u32 m0, s100, 7168
    s_mov_b32 s90, 57344
    buffer_load_dwordx4 v30, s[44:47], s90 offen  lds
    s_cmp_gt_u32 s60, 0
    s_cbranch_scc1 L_thr0_k16
    s_waitcnt vmcnt(4)
L_thr0_k16:
    s_cmp_gt_u32 s60, 1
    s_cbranch_scc1 L_thr1_k16
    s_waitcnt vmcnt(5)
L_thr1_k16:
    s_setprio 1
    s_mov_b32 s90, 131072
    buffer_load_dwordx4 v[112:115], v1, s[32:35], s90 offen offset:0 nt
    s_cmp_gt_u32 s60, 0
    s_cbranch_scc1 L_thr0_k17
    s_waitcnt vmcnt(3)
L_thr0_k17:
    s_cmp_gt_u32 s60, 1
    s_cbranch_scc1 L_thr1_k17
    s_waitcnt vmcnt(5)
L_thr1_k17:
    s_mov_b32 s90, 139264
    buffer_load_dwordx4 v[116:119], v1, s[32:35], s90 offen offset:0 nt
    s_mov_b32 s91, 400015
L_lw_3:
    ds_read_b32 v14, v12 offset:1036
    s_waitcnt lgkmcnt(0)
    v_readfirstlane_b32 s95, v14
    s_cmp_eq_u32 s95, 1
    s_cbranch_scc1 L_done_4
    s_sleep 1
    s_sub_u32 s91, s91, 1
    s_cbranch_scc0 L_lw_3
L_done_4:
    s_add_u32 m0, s100, 8192
    s_mov_b32 s90, 0
    buffer_load_dwordx4 v5, s[48:51], s90 offen  lds
    s_cmp_gt_u32 s60, 0
    s_cbranch_scc1 L_thr0_k18
    s_waitcnt vmcnt(4)
L_thr0_k18:
    s_cmp_gt_u32 s60, 1
    s_cbranch_scc1 L_thr1_k18
    s_waitcnt vmcnt(5)
L_thr1_k18:
    s_mov_b32 s90, 147456
    buffer_load_dwordx4 v[120:123], v1, s[32:35], s90 offen offset:0 nt
    s_cmp_gt_u32 s60, 0
    s_cbranch_scc1 L_thr0_k19
    s_waitcnt vmcnt(3)
L_thr0_k19:
    s_cmp_gt_u32 s60, 1
    s_cbranch_scc1 L_thr1_k19
    s_waitcnt vmcnt(5)
L_thr1_k19:
    s_mov_b32 s90, 155648
    buffer_load_dwordx4 v[124:127], v1, s[32:35], s90 offen offset:0 nt
    s_add_u32 m0, s100, 9216
    s_mov_b32 s90, 28672
    buffer_load_dwordx4 v6, s[48:51], s90 offen  lds
    s_cmp_gt_u32 s60, 0
    s_cbranch_scc1 L_thr0_k20
    s_waitcnt vmcnt(4)
L_thr0_k20:
    s_cmp_gt_u32 s60, 1
    s_cbranch_scc1 L_thr1_k20
    s_waitcnt vmcnt(5)
L_thr1_k20:
    s_mov_b32 s90, 163840
    buffer_load_dwordx4 v[128:131], v1, s[32:35], s90 offen offset:0 nt
    s_cmp_gt_u32 s60, 0
    s_cbranch_scc1 L_thr0_k21
    s_waitcnt vmcnt(3)
L_thr0_k21:
    s_cmp_gt_u32 s60, 1
    s_cbranch_scc1 L_thr1_k21
    s_waitcnt vmcnt(5)
L_thr1_k21:
    s_waitcnt vmcnt(11)
    s_mov_b32 s90, 172032
    buffer_load_dwordx4 v[132:135], v1, s[32:35], s90 offen offset:0 nt
    s_add_u32 m0, s100, 10240
    s_mov_b32 s90, 57344
    buffer_load_dwordx4 v5, s[48:51], s90 offen  lds
    s_cmp_gt_u32 s60, 0
    s_cbranch_scc1 L_thr0_k22
    s_waitcnt vmcnt(4)
L_thr0_k22:
    s_cmp_gt_u32 s60, 1
    s_cbranch_scc1 L_thr1_k22
    s_waitcnt vmcnt(5)
L_thr1_k22:
    s_waitcnt vmcnt(11)
    s_mov_b32 s90, 180224
    buffer_load_dwordx4 v[136:139], v1, s[32:35], s90 offen offset:0 nt
    s_cmp_gt_u32 s60, 0
    s_cbranch_scc1 L_thr0_k23
    s_waitcnt vmcnt(3)
L_thr0_k23:
    s_cmp_gt_u32 s60, 1
    s_cbranch_scc1 L_thr1_k23
    s_waitcnt vmcnt(5)
L_thr1_k23:
    s_waitcnt vmcnt(11)
    s_mov_b32 s90, 188416
    buffer_load_dwordx4 v[140:143], v1, s[32:35], s90 offen offset:0 nt
    s_add_u32 m0, s100, 11264
    s_mov_b32 s90, 86016
    buffer_load_dwordx4 v6, s[48:51], s90 offen  lds
    s_cmp_gt_u32 s60, 0
    s_cbranch_scc1 L_thr0_k24
    s_waitcnt vmcnt(4)
L_thr0_k24:
    s_cmp_gt_u32 s60, 1
    s_cbranch_scc1 L_thr1_k24
    s_waitcnt vmcnt(5)
L_thr1_k24:
    s_waitcnt vmcnt(11)
    s_setprio 0
    s_mov_b32 s90, 196608
    buffer_load_dwordx4 v[144:147], v1, s[32:35], s90 offen offset:0 nt
    s_cmp_gt_u32 s60, 0
    s_cbranch_scc1 L_thr0_k25
    s_waitcnt vmcnt(3)
L_thr0_k25:
    s_cmp_gt_u32 s60, 1
    s_cbranch_scc1 L_thr1_k25
    s_waitcnt vmcnt(5)
L_thr1_k25:
    s_waitcnt vmcnt(11)
    s_mov_b32 s90, 204800
    buffer_load_dwordx4 v[148:151], v1, s[32:35], s90 offen offset:0 nt
    s_add_u32 m0, s100, 12288
    s_mov_b32 s90, 114688
    buffer_load_dwordx4 v5, s[48:51], s90 offen  lds
    s_cmp_gt_u32 s60, 0
    s_cbranch_scc1 L_thr0_k26
    s_waitcnt vmcnt(4)
L_thr0_k26:
    s_cmp_gt_u32 s60, 1
    s_cbranch_scc1 L_thr1_k26
    s_waitcnt vmcnt(5)
L_thr1_k26:
    s_waitcnt vmcnt(11)
    s_mov_b32 s90, 212992
    buffer_load_dwordx4 v[152:155], v1, s[32:35], s90 offen offset:0 nt
    s_cmp_gt_u32 s60, 0
    s_cbranch_scc1 L_thr0_k27
    s_waitcnt vmcnt(3)
L_thr0_k27:
    s_cmp_gt_u32 s60, 1
    s_cbranch_scc1 L_thr1_k27
    s_waitcnt vmcnt(5)
L_thr1_k27:
    s_waitcnt vmcnt(11)
    s_mov_b32 s90, 221184
    buffer_load_dwordx4 v[156:159], v1, s[32:35], s90 offen offset:0 nt
    s_add_u32 m0, s100, 13312
    s_mov_b32 s90, 143360
    buffer_load_dwordx4 v6, s[48:51], s90 offen  lds
    s_cmp_gt_u32 s60, 0
    s_cbranch_scc1 L_thr0_k28
    s_waitcnt vmcnt(4)
L_thr0_k28:
    s_cmp_gt_u32 s60, 1
    s_cbranch_scc1 L_thr1_k28
    s_waitcnt vmcnt(5)
L_thr1_k28:
    s_waitcnt vmcnt(11)
    s_mov_b32 s90, 229376
    buffer_load_dwordx4 v[160:163], v1, s[32:35], s90 offen offset:0 nt
    s_cmp_gt_u32 s60, 0
    s_cbranch_scc1 L_thr0_k29
    s_waitcnt vmcnt(3)
L_thr0_k29:
    s_cmp_gt_u32 s60, 1
    s_cbranch_scc1 L_thr1_k29
    s_waitcnt vmcnt(5)
L_thr1_k29:
    s_waitcnt vmcnt(11)
    s_mov_b32 s90, 237568
    buffer_load_dwordx4 v[164:167], v1, s[32:35], s90 offen offset:0 nt
    s_add_u32 m0, s100, 14336
    s_mov_b32 s90, 172032
    buffer_load_dwordx4 v5, s[48:51], s90 offen  lds
    s_cmp_gt_u32 s60, 0
    s_cbranch_scc1 L_thr0_k30
    s_waitcnt vmcnt(4)
L_thr0_k30:
    s_cmp_gt_u32 s60, 1
    s_cbranch_scc1 L_thr1_k30
    s_waitcnt vmcnt(5)
L_thr1_k30:
    s_waitcnt vmcnt(11)
    s_mov_b32 s90, 245760
    buffer_load_dwordx4 v[168:171], v1, s[32:35], s90 offen offset:0 nt
    s_cmp_gt_u32 s60, 0
    s_cbranch_scc1 L_thr0_k31
    s_waitcnt vmcnt(3)
L_thr0_k31:
    s_cmp_gt_u32 s60, 1
    s_cbranch_scc1 L_thr1_k31
    s_waitcnt vmcnt(5)
L_thr1_k31:
    s_waitcnt vmcnt(11)
    s_mov_b32 s90, 253952
    buffer_load_dwordx4 v[172:175], v1, s[32:35], s90 offen offset:0 nt
    s_add_u32 m0, s100, 15360
    s_mov_b32 s90, 200704
    buffer_load_dwordx4 v6, s[48:51], s90 offen  lds
    s_cmp_gt_u32 s60, 0
    s_cbranch_scc1 L_thr0_k32
    s_waitcnt vmcnt(4)
L_thr0_k32:
    s_cmp_gt_u32 s60, 1
    s_cbranch_scc1 L_thr1_k32
    s_waitcnt vmcnt(5)
L_thr1_k32:
    s_waitcnt vmcnt(11)
    s_setprio 3
    buffer_load_dwordx4 v[176:179], v2, s[36:39], 0 offen offset:0 nt
    s_cmp_gt_u32 s60, 0
    s_cbranch_scc1 L_thr0_k33
    s_waitcnt vmcnt(3)
L_thr0_k33:
    s_cmp_gt_u32 s60, 1
    s_cbranch_scc1 L_thr1_k33
    s_waitcnt vmcnt(5)
L_thr1_k33:
    s_waitcnt vmcnt(11)
    s_mov_b32 s90, 8192
    buffer_load_dwordx4 v[180:183], v2, s[36:39], s90 offen offset:0 nt
    s_cmp_gt_u32 s60, 0
    s_cbranch_scc1 L_thr0_k34
    s_waitcnt vmcnt(3)
L_thr0_k34:
    s_cmp_gt_u32 s60, 1
    s_cbranch_scc1 L_thr1_k34
    s_waitcnt vmcnt(4)
L_thr1_k34:
    s_waitcnt vmcnt(10)
    s_mov_b32 s90, 16384
    buffer_load_dwordx4 v[184:187], v2, s[36:39], s90 offen offset:0 nt
    s_cmp_gt_u32 s60, 0
    s_cbranch_scc1 L_thr0_k35
    s_waitcnt vmcnt(2)
L_thr0_k35:
    s_cmp_gt_u32 s60, 1
    s_cbranch_scc1 L_thr1_k35
    s_waitcnt vmcnt(4)
L_thr1_k35:
    s_waitcnt vmcnt(10)
    s_mov_b32 s90, 24576
    buffer_load_dwordx4 v[188:191], v2, s[36:39], s90 offen offset:0 nt
    s_branch L_join
L_aux:
    s_setprio 3
    v_lshlrev_b32 v3, 4, v0
    v_add_u32 v3, 32768, v3
    v_add_u32 v4, 0x10000, v3
    s_cmp_ge_u32 s83, 3
    s_cbranch_scc1 L_aux_idle
    s_mov_b32 s91, 400015
L_lw_5:
    ds_read_b32 v14, v12 offset:1028
    s_waitcnt lgkmcnt(0)
    v_readfirstlane_b32 s95, v14
    s_cmp_eq_u32 s95, 8
    s_cbranch_scc1 L_done_6
    s_sub_u32 s91, s91, 1
    s_cbranch_scc0 L_lw_5
L_done_6:
    ds_read_b128 v[112:115], v3 offset:12288
    ds_read_b128 v[116:119], v3 offset:13312
    ds_read_b128 v[120:123], v3 offset:28672
    ds_read_b128 v[124:127], v3 offset:29696
    ds_read_b128 v[128:131], v3 offset:45056
    ds_read_b128 v[132:135], v3 offset:46080
    ds_read_b128 v[136:139], v3 offset:61440
    ds_read_b128 v[140:143], v3 offset:62464
    s_waitcnt lgkmcnt(0)
    ds_read_b128 v[144:147], v4 offset:12288
    ds_read_b128 v[148:151], v4 offset:13312
    ds_read_b128 v[152:155], v4 offset:28672
    ds_read_b128 v[156:159], v4 offset:29696
    ds_read_b128 v[160:163], v4 offset:45056
    ds_read_b128 v[164:167], v4 offset:46080
    ds_read_b128 v[168:171], v4 offset:61440
    ds_read_b128 v[172:175], v4 offset:62464
    s_waitcnt lgkmcnt(0)
    v_pk_add_f32 v[16:17], v[112:113], v[120:121]
    v_pk_add_f32 v[18:19], v[114:115], v[122:123]
    v_pk_add_f32 v[20:21], v[116:117], v[124:125]
    v_pk_add_f32 v[22:23], v[118:119], v[126:127]
    v_pk_add_f32 v[16:17], v[16:17], v[128:129]
    v_pk_add_f32 v[18:19], v[18:19], v[130:131]
    v_pk_add_f32 v[20:21], v[20:21], v[132:133]
    v_pk_add_f32 v[22:23], v[22:23], v[134:135]
    v_pk_add_f32 v[16:17], v[16:17], v[136:137]
    v_pk_add_f32 v[18:19], v[18:19], v[138:139]
    v_pk_add_f32 v[20:21], v[20:21], v[140:141]
    v_pk_add_f32 v[22:23], v[22:23], v[142:143]
    v_pk_add_f32 v[16:17], v[16:17], v[144:145]
    v_pk_add_f32 v[18:19], v[18:19], v[146:147]
    v_pk_add_f32 v[20:21], v[20:21], v[148:149]
    v_pk_add_f32 v[22:23], v[22:23], v[150:151]
    v_pk_add_f32 v[16:17], v[16:17], v[152:153]
    v_pk_add_f32 v[18:19], v[18:19], v[154:155]
    v_pk_add_f32 v[20:21], v[20:21], v[156:157]
    v_pk_add_f32 v[22:23], v[22:23], v[158:159]
    v_pk_add_f32 v[16:17], v[16:17], v[160:161]
    v_pk_add_f32 v[18:19], v[18:19], v[162:163]
    v_pk_add_f32 v[20:21], v[20:21], v[164:165]
    v_pk_add_f32 v[22:23], v[22:23], v[166:167]
    v_pk_add_f32 v[16:17], v[16:17], v[168:169]
    v_pk_add_f32 v[18:19], v[18:19], v[170:171]
    v_pk_add_f32 v[20:21], v[20:21], v[172:173]
    v_pk_add_f32 v[22:23], v[22:23], v[174:175]
    v_and_b32 v24, 7, v0
    v_lshrrev_b32 v31, 4, v0
    s_cmp_ge_u32 s83, 1
    s_cbranch_scc1 L_aux_mod
    s_lshr_b32 s95, s3, 1
    s_lshl_b32 s95, s95, 11
    s_and_b32 s96, s3, 1
    s_lshl_b32 s96, s96, 7
    s_add_u32 s95, s95, s96
    s_add_u32 s95, s95, 1572864
    v_lshlrev_b32 v4, 4, v24
    v_and_b32 v24, 1, v31
    v_lshl_add_u32 v4, v24, 10, v4
    v_lshrrev_b32 v24, 1, v31
    v_lshl_add_u32 v4, v24, 8, v4
    v_add_u32 v4, s95, v4
    v_bfe_u32 v24, v0, 3, 1
    v_mul_u32_u24 v24, 512, v24
    v_add_u32 v4, v4, v24
    v_mov_b32_dpp v16, v20 row_ror:8 row_mask:0xf bank_mask:0xc
    v_mov_b32_dpp v17, v21 row_ror:8 row_mask:0xf bank_mask:0xc
    v_mov_b32_dpp v18, v22 row_ror:8 row_mask:0xf bank_mask:0xc
    v_mov_b32_dpp v19, v23 row_ror:8 row_mask:0xf bank_mask:0xc
    v_cvt_pk_bf16_f32 v16, 0, v16
    v_cvt_pk_bf16_f32 v17, 0, v17
    v_cvt_pk_bf16_f32 v18, 0, v18
    v_cvt_pk_bf16_f32 v19, 0, v19
    v_or_b32 v16, s85, v16
    v_or_b32 v17, s86, v17
    v_or_b32 v18, s87, v18
    v_or_b32 v19, s88, v19
    buffer_store_dwordx4 v[16:19], v4, s[40:43], 0 offen sc1
    s_branch L_aux_idle
L_aux_mod:
    s_lshl_b32 s95, s3, 7
    s_add_u32 s95, s95, 61440
    v_lshlrev_b32 v4, 13, v24
    v_lshl_add_u32 v4, v31, 4, v4
    v_add_u32 v4, s95, v4
    v_bfe_u32 v24, v0, 3, 1
    v_mul_u32_u24 v24, 64, v24
    v_add_u32 v4, v4, v24
    v_mov_b32_dpp v16, v20 row_ror:8 row_mask:0xf bank_mask:0xc
    v_mov_b32_dpp v17, v21 row_ror:8 row_mask:0xf bank_mask:0xc
    v_mov_b32_dpp v18, v22 row_ror:8 row_mask:0xf bank_mask:0xc
    v_mov_b32_dpp v19, v23 row_ror:8 row_mask:0xf bank_mask:0xc
    v_cvt_pk_bf16_f32 v16, 0, v16
    v_cvt_pk_bf16_f32 v17, 0, v17
    v_cvt_pk_bf16_f32 v18, 0, v18
    v_cvt_pk_bf16_f32 v19, 0, v19
    v_or_b32 v16, s85, v16
    v_or_b32 v17, s86, v17
    v_or_b32 v18, s87, v18
    v_or_b32 v19, s88, v19
    buffer_store_dwordx4 v[16:19], v4, s[40:43], 0 offen sc1
L_aux_idle:
    ds_write_b32 v12, v13 offset:1036
    s_mov_b32 s97, 0
    s_branch L_aux_go
L_aux_late:
    s_mov_b32 s97, 1
L_aux_go:
    s_nop 4
    s_lshl_b32 s95, s81, 14
    s_lshl_b32 s96, s80, 11
    s_add_u32 s95, s95, s96
    s_add_u32 s95, s95, 131072
    v_lshlrev_b32 v3, 4, v0
    v_and_b32 v4, 3, v0
    v_lshlrev_b32 v4, 4, v4
    v_bfe_u32 v31, v0, 2, 2
    v_lshl_add_u32 v4, v31, 9, v4
    v_lshrrev_b32 v31, 4, v0
    v_lshl_add_u32 v4, v31, 6, v4
    v_add_u32 v4, s95, v4
    v_mov_b32 v25, 1
    v_mov_b32 v31, 0
    s_setprio 3
    s_cmp_eq_u32 s97, 1
    s_cbranch_scc1 L_aux_13
    s_cmp_gt_u32 s60, 0
    s_cbranch_scc1 L_thr0_a4
    s_waitcnt vmcnt(2)
L_thr0_a4:
    s_cmp_gt_u32 s60, 1
    s_cbranch_scc1 L_thr1_a4
    s_waitcnt vmcnt(3)
L_thr1_a4:
    s_mov_b32 s90, 32768
    buffer_load_dwordx4 v[64:67], v1, s[32:35], s90 offen offset:0 nt
    s_add_u32 m0, s100, 0
    s_mov_b32 s90, 0
    buffer_load_dwordx4 v29, s[44:47], s90 offen  lds
    s_add_u32 m0, s100, 1024
    s_mov_b32 s90, 8192
    buffer_load_dwordx4 v30, s[44:47], s90 offen  lds
    s_cmp_gt_u32 s60, 0
    s_cbranch_scc1 L_thr0_a5
    s_waitcnt vmcnt(4)
L_thr0_a5:
    s_cmp_gt_u32 s60, 1
    s_cbranch_scc1 L_thr1_a5
    s_waitcnt vmcnt(5)
L_thr1_a5:
    s_waitcnt vmcnt(6)
    s_mov_b32 s90, 40960
    buffer_load_dwordx4 v[68:71], v1, s[32:35], s90 offen offset:0 nt
    s_add_u32 m0, s100, 2048
    s_mov_b32 s90, 16384
    buffer_load_dwordx4 v29, s[44:47], s90 offen  lds
    s_cmp_gt_u32 s60, 0
    s_cbranch_scc1 L_thr0_a6
    s_waitcnt vmcnt(5)
L_thr0_a6:
    s_cmp_gt_u32 s60, 1
    s_cbranch_scc1 L_thr1_a6
    s_waitcnt vmcnt(6)
L_thr1_a6:
    s_waitcnt vmcnt(7)
    s_mov_b32 s90, 49152
    buffer_load_dwordx4 v[72:75], v1, s[32:35], s90 offen offset:0 nt
    s_cmp_gt_u32 s60, 0
    s_cbranch_scc1 L_thr0_a7
    s_waitcnt vmcnt(5)
L_thr0_a7:
    s_cmp_gt_u32 s60, 1
    s_cbranch_scc1 L_thr1_a7
    s_waitcnt vmcnt(6)
L_thr1_a7:
    s_waitcnt vmcnt(7)
    s_mov_b32 s90, 57344
    buffer_load_dwordx4 v[76:79], v1, s[32:35], s90 offen offset:0 nt
    s_add_u32 m0, s100, 3072
    s_mov_b32 s90, 24576
    buffer_load_dwordx4 v30, s[44:47], s90 offen  lds
    s_cmp_gt_u32 s60, 0
    s_cbranch_scc1 L_thr0_a8
    s_waitcnt vmcnt(4)
L_thr0_a8:
    s_cmp_gt_u32 s60, 1
    s_cbranch_scc1 L_thr1_a8
    s_waitcnt vmcnt(7)
L_thr1_a8:
    s_waitcnt vmcnt(8)
    s_mov_b32 s90, 65536
    buffer_load_dwordx4 v[80:83], v1, s[32:35], s90 offen offset:0 nt
    s_cmp_gt_u32 s60, 0
    s_cbranch_scc1 L_thr0_a9
    s_waitcnt vmcnt(3)
L_thr0_a9:
    s_cmp_gt_u32 s60, 1
    s_cbranch_scc1 L_thr1_a9
    s_waitcnt vmcnt(5)
L_thr1_a9:
    s_waitcnt vmcnt(8)
    s_mov_b32 s90, 73728
    buffer_load_dwordx4 v[84:87], v1, s[32:35], s90 offen offset:0 nt
    s_add_u32 m0, s100, 4096
    s_mov_b32 s90, 32768
    buffer_load_dwordx4 v29, s[44:47], s90 offen  lds
    s_cmp_gt_u32 s60, 0
    s_cbranch_scc1 L_thr0_a10
    s_waitcnt vmcnt(4)
L_thr0_a10:
    s_cmp_gt_u32 s60, 1
    s_cbranch_scc1 L_thr1_a10
    s_waitcnt vmcnt(5)
L_thr1_a10:
    s_waitcnt vmcnt(7)
    s_mov_b32 s90, 81920
    buffer_load_dwordx4 v[88:91], v1, s[32:35], s90 offen offset:0 nt
    s_cmp_gt_u32 s60, 0
    s_cbranch_scc1 L_thr0_a11
    s_waitcnt vmcnt(3)
L_thr0_a11:
    s_cmp_gt_u32 s60, 1
    s_cbranch_scc1 L_thr1_a11
    s_waitcnt vmcnt(5)
L_thr1_a11:
    s_waitcnt vmcnt(6)
    s_mov_b32 s90, 90112
    buffer_load_dwordx4 v[92:95], v1, s[32:35], s90 offen offset:0 nt
    s_add_u32 m0, s100, 5120
    s_mov_b32 s90, 40960
    buffer_load_dwordx4 v30, s[44:47], s90 offen  lds
    s_cmp_gt_u32 s60, 0
    s_cbranch_scc1 L_thr0_a12
    s_waitcnt vmcnt(4)
L_thr0_a12:
    s_cmp_gt_u32 s60, 1
    s_cbranch_scc1 L_thr1_a12
    s_waitcnt vmcnt(5)
L_thr1_a12:
    s_waitcnt vmcnt(7)
    s_mov_b32 s90, 98304
    buffer_load_dwordx4 v[96:99], v1, s[32:35], s90 offen offset:0 nt
    s_cmp_gt_u32 s60, 0
    s_cbranch_scc1 L_thr0_a13
    s_waitcnt vmcnt(3)
L_thr0_a13:
    s_cmp_gt_u32 s60, 1
    s_cbranch_scc1 L_thr1_a13
    s_waitcnt vmcnt(5)
L_thr1_a13:
    s_waitcnt vmcnt(6)
L_aux_13:
    s_mov_b32 s90, 106496
    buffer_load_dwordx4 v[100:103], v1, s[32:35], s90 offen offset:0 nt
    s_add_u32 m0, s100, 6144
    s_mov_b32 s90, 49152
    buffer_load_dwordx4 v29, s[44:47], s90 offen  lds
    s_cmp_gt_u32 s60, 0
    s_cbranch_scc1 L_thr0_a14
    s_waitcnt vmcnt(4)
L_thr0_a14:
    s_cmp_gt_u32 s60, 1
    s_cbranch_scc1 L_thr1_a14
    s_waitcnt vmcnt(5)
L_thr1_a14:
    s_waitcnt vmcnt(7)
    s_mov_b32 s90, 114688
    buffer_load_dwordx4 v[104:107], v1, s[32:35], s90 offen offset:0 nt
    s_cmp_gt_u32 s60, 0
    s_cbranch_scc1 L_thr0_a15
    s_waitcnt vmcnt(3)
L_thr0_a15:
    s_cmp_gt_u32 s60, 1
    s_cbranch_scc1 L_thr1_a15
    s_waitcnt vmcnt(5)
L_thr1_a15:
    s_waitcnt vmcnt(6)
    s_mov_b32 s90, 122880
    buffer_load_dwordx4 v[108:111], v1, s[32:35], s90 offen offset:0 nt
    s_add_u32 m0, s100, 7168
    s_mov_b32 s90, 57344
    buffer_load_dwordx4 v30, s[44:47], s90 offen  lds
    s_cmp_gt_u32 s60, 0
    s_cbranch_scc1 L_thr0_a16
    s_waitcnt vmcnt(4)
L_thr0_a16:
    s_cmp_gt_u32 s60, 1
    s_cbranch_scc1 L_thr1_a16
    s_waitcnt vmcnt(5)
L_thr1_a16:
    s_waitcnt vmcnt(7)
    s_mov_b32 s90, 131072
    buffer_load_dwordx4 v[112:115], v1, s[32:35], s90 offen offset:0 nt
    s_cmp_gt_u32 s60, 0
    s_cbranch_scc1 L_thr0_a17
    s_waitcnt vmcnt(3)
L_thr0_a17:
    s_cmp_gt_u32 s60, 1
    s_cbranch_scc1 L_thr1_a17
    s_waitcnt vmcnt(5)
L_thr1_a17:
    s_waitcnt vmcnt(6)
    s_mov_b32 s90, 139264
    buffer_load_dwordx4 v[116:119], v1, s[32:35], s90 offen offset:0 nt
    s_add_u32 m0, s100, 8192
    s_mov_b32 s90, 0
    buffer_load_dwordx4 v5, s[48:51], s90 offen  lds
    s_cmp_gt_u32 s60, 0
    s_cbranch_scc1 L_thr0_a18
    s_waitcnt vmcnt(4)
L_thr0_a18:
    s_cmp_gt_u32 s60, 1
    s_cbranch_scc1 L_thr1_a18
    s_waitcnt vmcnt(5)
L_thr1_a18:
    s_waitcnt vmcnt(7)
    s_mov_b32 s90, 147456
    buffer_load_dwordx4 v[120:123], v1, s[32:35], s90 offen offset:0 nt
    s_cmp_gt_u32 s60, 0
    s_cbranch_scc1 L_thr0_a19
    s_waitcnt vmcnt(3)
L_thr0_a19:
    s_cmp_gt_u32 s60, 1
    s_cbranch_scc1 L_thr1_a19
    s_waitcnt vmcnt(5)
L_thr1_a19:
    s_waitcnt vmcnt(6)
    s_mov_b32 s90, 155648
    buffer_load_dwordx4 v[124:127], v1, s[32:35], s90 offen offset:0 nt
    s_add_u32 m0, s100, 9216
    s_mov_b32 s90, 28672
    buffer_load_dwordx4 v6, s[48:51], s90 offen  lds
    s_cmp_gt_u32 s60, 0
    s_cbranch_scc1 L_thr0_a20
    s_waitcnt vmcnt(4)
L_thr0_a20:
    s_cmp_gt_u32 s60, 1
    s_cbranch_scc1 L_thr1_a20
    s_waitcnt vmcnt(5)
L_thr1_a20:
    s_waitcnt vmcnt(7)
    s_mov_b32 s90, 163840
    buffer_load_dwordx4 v[128:131], v1, s[32:35], s90 offen offset:0 nt
    s_cmp_gt_u32 s60, 0
    s_cbranch_scc1 L_thr0_a21
    s_waitcnt vmcnt(3)
L_thr0_a21:
    s_cmp_gt_u32 s60, 1
    s_cbranch_scc1 L_thr1_a21
    s_waitcnt vmcnt(5)
L_thr1_a21:
    s_waitcnt vmcnt(6)
    s_mov_b32 s90, 172032
    buffer_load_dwordx4 v[132:135], v1, s[32:35], s90 offen offset:0 nt
    s_add_u32 m0, s100, 10240
    s_mov_b32 s90, 57344
    buffer_load_dwordx4 v5, s[48:51], s90 offen  lds
    s_cmp_gt_u32 s60, 0
    s_cbranch_scc1 L_thr0_a22
    s_waitcnt vmcnt(4)
L_thr0_a22:
    s_cmp_gt_u32 s60, 1
    s_cbranch_scc1 L_thr1_a22
    s_waitcnt vmcnt(5)
L_thr1_a22:
    s_waitcnt vmcnt(7)
    s_mov_b32 s90, 180224
    buffer_load_dwordx4 v[136:139], v1, s[32:35], s90 offen offset:0 nt
    s_cmp_gt_u32 s60, 0
    s_cbranch_scc1 L_thr0_a23
    s_waitcnt vmcnt(3)
L_thr0_a23:
    s_cmp_gt_u32 s60, 1
    s_cbranch_scc1 L_thr1_a23
    s_waitcnt vmcnt(5)
L_thr1_a23:
    s_waitcnt vmcnt(6)
    buffer_load_dwordx4 v[248:251], v4, s[40:43], 0 offen offset:0 sc1
    buffer_load_dwordx4 v[252:255], v4, s[40:43], 0 offen offset:256 sc1
    s_mov_b32 s90, 188416
    buffer_load_dwordx4 v[140:143], v1, s[32:35], s90 offen offset:0 nt
    s_add_u32 m0, s100, 11264
    s_mov_b32 s90, 86016
    buffer_load_dwordx4 v6, s[48:51], s90 offen  lds
    s_cmp_gt_u32 s60, 0
    s_cbranch_scc1 L_thr0_a24
    s_waitcnt vmcnt(6)
L_thr0_a24:
    s_cmp_gt_u32 s60, 1
    s_cbranch_scc1 L_thr1_a24
    s_waitcnt vmcnt(7)
L_thr1_a24:
    s_waitcnt vmcnt(9)
    s_mov_b32 s90, 196608
    buffer_load_dwordx4 v[144:147], v1, s[32:35], s90 offen offset:0 nt
    s_cmp_gt_u32 s60, 0
    s_cbranch_scc1 L_thr0_a25
    s_waitcnt vmcnt(5)
L_thr0_a25:
    s_cmp_gt_u32 s60, 1
    s_cbranch_scc1 L_thr1_a25
    s_waitcnt vmcnt(7)
L_thr1_a25:
    s_waitcnt vmcnt(8)
    s_waitcnt vmcnt(3)
    v_xor_b32 v24, s85, v248
    v_bitop3_b32 v24, v24, v249, s86 bitop3:0xf6
    v_bitop3_b32 v24, v24, v250, s87 bitop3:0xf6
    v_bitop3_b32 v24, v24, v251, s88 bitop3:0xf6
    v_bitop3_b32 v24, v24, v252, s85 bitop3:0xf6
    v_bitop3_b32 v24, v24, v253, s86 bitop3:0xf6
    v_bitop3_b32 v24, v24, v254, s87 bitop3:0xf6
    v_bitop3_b32 v24, v24, v255, s88 bitop3:0xf6
    v_and_b32 v24, 0xff, v24
    v_cmp_ne_u32 vcc, 0, v24
    s_cbranch_vccz L_qok_25
    buffer_load_dwordx4 v[248:251], v4, s[40:43], 0 offen offset:0 sc1
    buffer_load_dwordx4 v[252:255], v4, s[40:43], 0 offen offset:256 sc1
    s_mov_b32 s90, 204800
    buffer_load_dwordx4 v[148:151], v1, s[32:35], s90 offen offset:0 nt
    s_add_u32 m0, s100, 12288
    s_mov_b32 s90, 114688
    buffer_load_dwordx4 v5, s[48:51], s90 offen  lds
    s_cmp_gt_u32 s60, 0
    s_cbranch_scc1 L_thr0_a26
    s_waitcnt vmcnt(6)
L_thr0_a26:
    s_mov_b32 s90, 212992
    buffer_load_dwordx4 v[152:155], v1, s[32:35], s90 offen offset:0 nt
    s_cmp_gt_u32 s60, 0
    s_cbranch_scc1 L_thr0_a27
    s_waitcnt vmcnt(5)
L_thr0_a27:
    s_cmp_gt_u32 s60, 1
    s_cbranch_scc1 L_thr1_a27
    s_waitcnt vmcnt(7)
L_thr1_a27:
    s_waitcnt vmcnt(3)
    v_xor_b32 v24, s85, v248
    v_bitop3_b32 v24, v24, v249, s86 bitop3:0xf6
    v_bitop3_b32 v24, v24, v250, s87 bitop3:0xf6
    v_bitop3_b32 v24, v24, v251, s88 bitop3:0xf6
    v_bitop3_b32 v24, v24, v252, s85 bitop3:0xf6
    v_bitop3_b32 v24, v24, v253, s86 bitop3:0xf6
    v_bitop3_b32 v24, v24, v254, s87 bitop3:0xf6
    v_bitop3_b32 v24, v24, v255, s88 bitop3:0xf6
    v_and_b32 v24, 0xff, v24
    v_cmp_ne_u32 vcc, 0, v24
    s_cbranch_vccz L_qok_27
    buffer_load_dwordx4 v[248:251], v4, s[40:43], 0 offen offset:0 sc1
    buffer_load_dwordx4 v[252:255], v4, s[40:43], 0 offen offset:256 sc1
    s_mov_b32 s90, 221184
    buffer_load_dwordx4 v[156:159], v1, s[32:35], s90 offen offset:0 nt
    s_add_u32 m0, s100, 13312
    s_mov_b32 s90, 143360
    buffer_load_dwordx4 v6, s[48:51], s90 offen  lds
    s_cmp_gt_u32 s60, 0
    s_cbranch_scc1 L_thr0_a28
    s_waitcnt vmcnt(6)
L_thr0_a28:
    s_mov_b32 s90, 229376
    buffer_load_dwordx4 v[160:163], v1, s[32:35], s90 offen offset:0 nt
    s_cmp_gt_u32 s60, 0
    s_cbranch_scc1 L_thr0_a29
    s_waitcnt vmcnt(5)
L_thr0_a29:
    s_cmp_gt_u32 s60, 1
    s_cbranch_scc1 L_thr1_a29
    s_waitcnt vmcnt(7)
L_thr1_a29:
    s_waitcnt vmcnt(3)
    v_xor_b32 v24, s85, v248
    v_bitop3_b32 v24, v24, v249, s86 bitop3:0xf6
    v_bitop3_b32 v24, v24, v250, s87 bitop3:0xf6
    v_bitop3_b32 v24, v24, v251, s88 bitop3:0xf6
    v_bitop3_b32 v24, v24, v252, s85 bitop3:0xf6
    v_bitop3_b32 v24, v24, v253, s86 bitop3:0xf6
    v_bitop3_b32 v24, v24, v254, s87 bitop3:0xf6
    v_bitop3_b32 v24, v24, v255, s88 bitop3:0xf6
    v_and_b32 v24, 0xff, v24
    v_cmp_ne_u32 vcc, 0, v24
    s_cbranch_vccz L_qok_29
    buffer_load_dwordx4 v[248:251], v4, s[40:43], 0 offen offset:0 sc1
    buffer_load_dwordx4 v[252:255], v4, s[40:43], 0 offen offset:256 sc1
    s_mov_b32 s90, 237568
    buffer_load_dwordx4 v[164:167], v1, s[32:35], s90 offen offset:0 nt
    s_add_u32 m0, s100, 14336
    s_mov_b32 s90, 172032
    buffer_load_dwordx4 v5, s[48:51], s90 offen  lds
    s_cmp_gt_u32 s60, 0
    s_cbranch_scc1 L_thr0_a30
    s_waitcnt vmcnt(6)
L_thr0_a30:
    s_mov_b32 s90, 245760
    buffer_load_dwordx4 v[168:171], v1, s[32:35], s90 offen offset:0 nt
    s_cmp_gt_u32 s60, 0
    s_cbranch_scc1 L_thr0_a31
    s_waitcnt vmcnt(5)
L_thr0_a31:
    s_cmp_gt_u32 s60, 1
    s_cbranch_scc1 L_thr1_a31
    s_waitcnt vmcnt(7)
L_thr1_a31:
    s_waitcnt vmcnt(3)
    v_xor_b32 v24, s85, v248
    v_bitop3_b32 v24, v24, v249, s86 bitop3:0xf6
    v_bitop3_b32 v24, v24, v250, s87 bitop3:0xf6
    v_bitop3_b32 v24, v24, v251, s88 bitop3:0xf6
    v_bitop3_b32 v24, v24, v252, s85 bitop3:0xf6
    v_bitop3_b32 v24, v24, v253, s86 bitop3:0xf6
    v_bitop3_b32 v24, v24, v254, s87 bitop3:0xf6
    v_bitop3_b32 v24, v24, v255, s88 bitop3:0xf6
    v_and_b32 v24, 0xff, v24
    v_cmp_ne_u32 vcc, 0, v24
    s_cbranch_vccz L_qok_31
    buffer_load_dwordx4 v[248:251], v4, s[40:43], 0 offen offset:0 sc1
    buffer_load_dwordx4 v[252:255], v4, s[40:43], 0 offen offset:256 sc1
    s_mov_b32 s90, 253952
    buffer_load_dwordx4 v[172:175], v1, s[32:35], s90 offen offset:0 nt
    s_add_u32 m0, s100, 15360
    s_mov_b32 s90, 200704
    buffer_load_dwordx4 v6, s[48:51], s90 offen  lds
    s_cmp_gt_u32 s60, 0
    s_cbranch_scc1 L_thr0_a32
    s_waitcnt vmcnt(6)
L_thr0_a32:
    buffer_load_dwordx4 v[176:179], v2, s[36:39], 0 offen offset:0 nt
    s_cmp_gt_u32 s60, 0
    s_cbranch_scc1 L_thr0_a33
    s_waitcnt vmcnt(5)
L_thr0_a33:
    s_cmp_gt_u32 s60, 1
    s_cbranch_scc1 L_thr1_a33
    s_waitcnt vmcnt(7)
L_thr1_a33:
    s_waitcnt vmcnt(3)
    v_xor_b32 v24, s85, v248
    v_bitop3_b32 v24, v24, v249, s86 bitop3:0xf6
    v_bitop3_b32 v24, v24, v250, s87 bitop3:0xf6
    v_bitop3_b32 v24, v24, v251, s88 bitop3:0xf6
    v_bitop3_b32 v24, v24, v252, s85 bitop3:0xf6
    v_bitop3_b32 v24, v24, v253, s86 bitop3:0xf6
    v_bitop3_b32 v24, v24, v254, s87 bitop3:0xf6
    v_bitop3_b32 v24, v24, v255, s88 bitop3:0xf6
    v_and_b32 v24, 0xff, v24
    v_cmp_ne_u32 vcc, 0, v24
    s_cbranch_vccz L_qok_33
    buffer_load_dwordx4 v[248:251], v4, s[40:43], 0 offen offset:0 sc1
    buffer_load_dwordx4 v[252:255], v4, s[40:43], 0 offen offset:256 sc1
    s_mov_b32 s90, 8192
    buffer_load_dwordx4 v[180:183], v2, s[36:39], s90 offen offset:0 nt
    s_cmp_gt_u32 s60, 0
    s_cbranch_scc1 L_thr0_a34
    s_waitcnt vmcnt(5)
L_thr0_a34:
    s_mov_b32 s90, 16384
    buffer_load_dwordx4 v[184:187], v2, s[36:39], s90 offen offset:0 nt
    s_cmp_gt_u32 s60, 0
    s_cbranch_scc1 L_thr0_a35
    s_waitcnt vmcnt(4)
L_thr0_a35:
    s_cmp_gt_u32 s60, 1
    s_cbranch_scc1 L_thr1_a35
    s_waitcnt vmcnt(6)
L_thr1_a35:
    s_waitcnt vmcnt(2)
    v_xor_b32 v24, s85, v248
    v_bitop3_b32 v24, v24, v249, s86 bitop3:0xf6
    v_bitop3_b32 v24, v24, v250, s87 bitop3:0xf6
    v_bitop3_b32 v24, v24, v251, s88 bitop3:0xf6
    v_bitop3_b32 v24, v24, v252, s85 bitop3:0xf6
    v_bitop3_b32 v24, v24, v253, s86 bitop3:0xf6
    v_bitop3_b32 v24, v24, v254, s87 bitop3:0xf6
    v_bitop3_b32 v24, v24, v255, s88 bitop3:0xf6
    v_and_b32 v24, 0xff, v24
    v_cmp_ne_u32 vcc, 0, v24
    s_cbranch_vccz L_qok_35
    buffer_load_dwordx4 v[248:251], v4, s[40:43], 0 offen offset:0 sc1
    buffer_load_dwordx4 v[252:255], v4, s[40:43], 0 offen offset:256 sc1
    s_mov_b32 s90, 24576
    buffer_load_dwordx4 v[188:191], v2, s[36:39], s90 offen offset:0 nt
    s_waitcnt vmcnt(1)
    s_mov_b32 s91, 400015
    v_xor_b32 v24, s85, v248
    v_bitop3_b32 v24, v24, v249, s86 bitop3:0xf6
    v_bitop3_b32 v24, v24, v250, s87 bitop3:0xf6
    v_bitop3_b32 v24, v24, v251, s88 bitop3:0xf6
    v_bitop3_b32 v24, v24, v252, s85 bitop3:0xf6
    v_bitop3_b32 v24, v24, v253, s86 bitop3:0xf6
    v_bitop3_b32 v24, v24, v254, s87 bitop3:0xf6
    v_bitop3_b32 v24, v24, v255, s88 bitop3:0xf6
    v_and_b32 v24, 0xff, v24
    v_cmp_ne_u32 vcc, 0, v24
    s_cbranch_vccz L_ok_8
L_poll_7:
    s_sleep 2
    s_and_b32 s95, s91, 3
    s_cbranch_scc1 L_q_soon
    s_cmp_lg_u32 s83, 2
    s_cbranch_scc1 L_noq2_9
    v_lshlrev_b32 v244, 4, v0
    v_lshrrev_b32 v245, 5, v0
    v_mul_u32_u24 v245, 15872, v245
    v_add_u32 v245, v245, v244
    s_lshl_b32 s95, s3, 9
    s_add_u32 s95, s95, 1703936
    ds_read_b128 v[240:243], v244 offset:20480
    s_waitcnt lgkmcnt(0)
    buffer_store_dwordx4 v[240:243], v245, s[40:43], s95 offen sc1
    s_add_u32 s95, s95, 32768
    s_nop 0
    ds_read_b128 v[240:243], v244 offset:21504
    s_waitcnt lgkmcnt(0)
    buffer_store_dwordx4 v[240:243], v245, s[40:43], s95 offen sc1
    s_add_u32 s95, s95, 32768
    s_nop 0
    ds_read_b128 v[240:243], v244 offset:22528
    s_waitcnt lgkmcnt(0)
    buffer_store_dwordx4 v[240:243], v245, s[40:43], s95 offen sc1
    s_add_u32 s95, s95, 32768
    s_nop 0
    ds_read_b128 v[240:243], v244 offset:23552
    s_waitcnt lgkmcnt(0)
    buffer_store_dwordx4 v[240:243], v245, s[40:43], s95 offen sc1
    s_add_u32 s95, s95, 32768
    s_nop 0
L_noq2_9:
L_q_soon:
    s_and_b32 s95, s91, 3
    s_cselect_b32 s95, 0, 1572864
    buffer_load_dwordx4 v[248:251], v4, s[40:43], s95 offen offset:0 sc1
    buffer_load_dwordx4 v[252:255], v4, s[40:43], s95 offen offset:256 sc1
    s_waitcnt vmcnt(0)
    v_xor_b32 v24, s85, v248
    v_bitop3_b32 v24, v24, v249, s86 bitop3:0xf6
    v_bitop3_b32 v24, v24, v250, s87 bitop3:0xf6
    v_bitop3_b32 v24, v24, v251, s88 bitop3:0xf6
    v_bitop3_b32 v24, v24, v252, s85 bitop3:0xf6
    v_bitop3_b32 v24, v24, v253, s86 bitop3:0xf6
    v_bitop3_b32 v24, v24, v254, s87 bitop3:0xf6
    v_bitop3_b32 v24, v24, v255, s88 bitop3:0xf6
    v_and_b32 v24, 0xff, v24
    v_cmp_ne_u32 vcc, 0, v24
    s_cbranch_vccz L_done_10
    s_sub_u32 s91, s91, 1
    s_cbranch_scc0 L_poll_7
L_done_10:
L_ok_8:
    s_nop 1
    v_perm_b32 v12, v249, v248, s93
    v_perm_b32 v13, v251, v250, s93
    v_perm_b32 v14, v253, v252, s93
    v_perm_b32 v15, v255, v254, s93
    ds_write_b128 v3, v[12:15] offset:0
    ds_write_b32 v31, v25 offset:1024
    s_branch L_join
L_qok_25:
    v_perm_b32 v12, v249, v248, s93
    v_perm_b32 v13, v251, v250, s93
    v_perm_b32 v14, v253, v252, s93
    v_perm_b32 v15, v255, v254, s93
    ds_write_b128 v3, v[12:15] offset:0
    ds_write_b32 v31, v25 offset:1024
    s_branch L_rest_25
L_qok_27:
    v_perm_b32 v12, v249, v248, s93
    v_perm_b32 v13, v251, v250, s93
    v_perm_b32 v14, v253, v252, s93
    v_perm_b32 v15, v255, v254, s93
    ds_write_b128 v3, v[12:15] offset:0
    ds_write_b32 v31, v25 offset:1024
    s_branch L_rest_27
L_qok_29:
    v_perm_b32 v12, v249, v248, s93
    v_perm_b32 v13, v251, v250, s93
    v_perm_b32 v14, v253, v252, s93
    v_perm_b32 v15, v255, v254, s93
    ds_write_b128 v3, v[12:15] offset:0
    ds_write_b32 v31, v25 offset:1024
    s_branch L_rest_29
L_qok_31:
    v_perm_b32 v12, v249, v248, s93
    v_perm_b32 v13, v251, v250, s93
    v_perm_b32 v14, v253, v252, s93
    v_perm_b32 v15, v255, v254, s93
    ds_write_b128 v3, v[12:15] offset:0
    ds_write_b32 v31, v25 offset:1024
    s_branch L_rest_31
L_qok_33:
    v_perm_b32 v12, v249, v248, s93
    v_perm_b32 v13, v251, v250, s93
    v_perm_b32 v14, v253, v252, s93
    v_perm_b32 v15, v255, v254, s93
    ds_write_b128 v3, v[12:15] offset:0
    ds_write_b32 v31, v25 offset:1024
    s_branch L_rest_33
L_qok_35:
    v_perm_b32 v12, v249, v248, s93
    v_perm_b32 v13, v251, v250, s93
    v_perm_b32 v14, v253, v252, s93
    v_perm_b32 v15, v255, v254, s93
    ds_write_b128 v3, v[12:15] offset:0
    ds_write_b32 v31, v25 offset:1024
    s_branch L_rest_35
L_rest_25:
    s_mov_b32 s90, 204800
    buffer_load_dwordx4 v[148:151], v1, s[32:35], s90 offen offset:0 nt
    s_add_u32 m0, s100, 12288
    s_mov_b32 s90, 114688
    buffer_load_dwordx4 v5, s[48:51], s90 offen  lds
    s_mov_b32 s90, 212992
    buffer_load_dwordx4 v[152:155], v1, s[32:35], s90 offen offset:0 nt
L_rest_27:
    s_mov_b32 s90, 221184
    buffer_load_dwordx4 v[156:159], v1, s[32:35], s90 offen offset:0 nt
    s_add_u32 m0, s100, 13312
    s_mov_b32 s90, 143360
    buffer_load_dwordx4 v6, s[48:51], s90 offen  lds
    s_mov_b32 s90, 229376
    buffer_load_dwordx4 v[160:163], v1, s[32:35], s90 offen offset:0 nt
L_rest_29:
    s_mov_b32 s90, 237568
    buffer_load_dwordx4 v[164:167], v1, s[32:35], s90 offen offset:0 nt
    s_add_u32 m0, s100, 14336
    s_mov_b32 s90, 172032
    buffer_load_dwordx4 v5, s[48:51], s90 offen  lds
    s_waitcnt vmcnt(7)
    s_mov_b32 s90, 245760
    buffer_load_dwordx4 v[168:171], v1, s[32:35], s90 offen offset:0 nt
L_rest_31:
    s_waitcnt vmcnt(6)
    s_mov_b32 s90, 253952
    buffer_load_dwordx4 v[172:175], v1, s[32:35], s90 offen offset:0 nt
    s_add_u32 m0, s100, 15360
    s_mov_b32 s90, 200704
    buffer_load_dwordx4 v6, s[48:51], s90 offen  lds
    s_waitcnt vmcnt(7)
    s_setprio 3
    buffer_load_dwordx4 v[176:179], v2, s[36:39], 0 offen offset:0 nt
L_rest_33:
    s_waitcnt vmcnt(6)
    s_mov_b32 s90, 8192
    buffer_load_dwordx4 v[180:183], v2, s[36:39], s90 offen offset:0 nt
    s_waitcnt vmcnt(6)
    s_mov_b32 s90, 16384
    buffer_load_dwordx4 v[184:187], v2, s[36:39], s90 offen offset:0 nt
L_rest_35:
    s_waitcnt vmcnt(5)
    s_mov_b32 s90, 24576
    buffer_load_dwordx4 v[188:191], v2, s[36:39], s90 offen offset:0 nt
L_join:
    s_lshl_b32 s95, s81, 13
    s_add_u32 s95, s95, 65536
    s_lshl_b32 s96, s84, 8
    s_add_u32 s96, s96, s95
    v_and_b32 v3, 15, v0
    v_lshlrev_b32 v3, 4, v3
    v_add_u32 v3, s96, v3
    s_lshl_b32 s96, s98, 6
    s_add_u32 s96, s96, s95
    v_and_b32 v4, 3, v0
    v_lshlrev_b32 v4, 4, v4
    v_add_u32 v4, s96, v4
    s_lshl_b32 s95, s81, 10
    s_lshl_b32 s96, s84, 7
    s_add_u32 s95, s95, s96
    v_and_b32 v24, 15, v0
    v_lshlrev_b32 v24, 3, v24
    v_lshrrev_b32 v31, 4, v0
    v_lshl_add_u32 v24, v31, 1, v24
    v_add_u32 v31, s95, v24
    buffer_load_ushort v24, v31, s[56:59], 0 offen
    buffer_load_dwordx4 v[240:243], v3, s[40:43], 0 offen offset:0 sc1
    s_mov_b32 s90, 4096
    buffer_load_dwordx4 v[244:247], v3, s[40:43], s90 offen offset:0 sc1
    buffer_load_dwordx4 v[248:251], v3, s[40:43], 0 offen offset:2048 sc1
    s_mov_b32 s90, 4096
    buffer_load_dwordx4 v[252:255], v4, s[40:43], s90 offen offset:2048 sc1
    s_cmp_gt_u32 s60, 0
    s_cbranch_scc1 L_thr0_v4
    s_waitcnt vmcnt(7)
L_thr0_v4:
    s_cmp_gt_u32 s60, 1
    s_cbranch_scc1 L_thr1_v4
    s_waitcnt vmcnt(8)
L_thr1_v4:
    s_mov_b32 s90, 32768
    buffer_load_dwordx4 v[192:195], v2, s[36:39], s90 offen offset:0 nt
    s_cmp_gt_u32 s60, 0
    s_cbranch_scc1 L_thr0_v5
    s_waitcnt vmcnt(7)
L_thr0_v5:
    s_cmp_gt_u32 s60, 1
    s_cbranch_scc1 L_thr1_v5
    s_waitcnt vmcnt(8)
L_thr1_v5:
    s_mov_b32 s90, 40960
    buffer_load_dwordx4 v[196:199], v2, s[36:39], s90 offen offset:0 nt
    s_mov_b32 s91, 400015
    v_mov_b32 v31, 0
    v_lshlrev_b32 v1, 4, v0
L_qf_11:
    ds_read_b32 v29, v31 offset:1024
    s_waitcnt lgkmcnt(0)
    v_readfirstlane_b32 s95, v29
    s_cmp_eq_u32 s95, 1
    s_cbranch_scc1 L_done_12
    s_sleep 1
    s_sub_u32 s91, s91, 1
    s_cbranch_scc0 L_qf_11
L_done_12:
    ds_read_b128 v[12:15], v1 offset:0
    s_waitcnt lgkmcnt(0)
    s_waitcnt vmcnt(39)
    v_mfma_f32_16x16x32_bf16 v[48:51], v[48:51], v[12:15], 0
    v_mfma_f32_16x16x32_bf16 v[52:55], v[52:55], v[12:15], 0
    v_mfma_f32_16x16x32_bf16 v[56:59], v[56:59], v[12:15], 0
    v_mfma_f32_16x16x32_bf16 v[60:63], v[60:63], v[12:15], 0
    s_waitcnt vmcnt(35)
    v_mfma_f32_16x16x32_bf16 v[64:67], v[64:67], v[12:15], 0
    v_mfma_f32_16x16x32_bf16 v[68:71], v[68:71], v[12:15], 0
    v_mfma_f32_16x16x32_bf16 v[72:75], v[72:75], v[12:15], 0
    v_mfma_f32_16x16x32_bf16 v[76:79], v[76:79], v[12:15], 0
    v_mov_b32_dpp v48, v48 quad_perm:[0,0,0,0] row_mask:0xf bank_mask:0xf
    v_mov_b32_dpp v52, v52 quad_perm:[0,0,0,0] row_mask:0xf bank_mask:0xf
    v_mov_b32_dpp v56, v56 quad_perm:[0,0,0,0] row_mask:0xf bank_mask:0xf
    v_mov_b32_dpp v60, v60 quad_perm:[0,0,0,0] row_mask:0xf bank_mask:0xf
    v_add_f32_dpp v48, v49, v48 quad_perm:[1,1,1,1] row_mask:0xf bank_mask:0xf
    v_add_f32_dpp v52, v53, v52 quad_perm:[1,1,1,1] row_mask:0xf bank_mask:0xf
    v_add_f32_dpp v56, v57, v56 quad_perm:[1,1,1,1] row_mask:0xf bank_mask:0xf
    v_add_f32_dpp v60, v61, v60 quad_perm:[1,1,1,1] row_mask:0xf bank_mask:0xf
    v_add_f32_dpp v48, v50, v48 quad_perm:[2,2,2,2] row_mask:0xf bank_mask:0xf
    v_add_f32_dpp v52, v54, v52 quad_perm:[2,2,2,2] row_mask:0xf bank_mask:0xf
    v_add_f32_dpp v56, v58, v56 quad_perm:[2,2,2,2] row_mask:0xf bank_mask:0xf
    v_add_f32_dpp v60, v62, v60 quad_perm:[2,2,2,2] row_mask:0xf bank_mask:0xf
    v_add_f32_dpp v48, v51, v48 quad_perm:[3,3,3,3] row_mask:0xf bank_mask:0xf
    v_add_f32_dpp v52, v55, v52 quad_perm:[3,3,3,3] row_mask:0xf bank_mask:0xf
    v_add_f32_dpp v56, v59, v56 quad_perm:[3,3,3,3] row_mask:0xf bank_mask:0xf
    v_add_f32_dpp v60, v63, v60 quad_perm:[3,3,3,3] row_mask:0xf bank_mask:0xf
    v_max_f32 v5, v48, v52
    v_max3_f32 v5, v5, v56, v60
    v_cvt_pk_bf16_f32 v48, 0, v48
    v_cvt_pk_bf16_f32 v52, 0, v52
    v_cvt_pk_bf16_f32 v56, 0, v56
    v_cvt_pk_bf16_f32 v60, 0, v60
    v_mul_f32 v48, 1035273459, v48
    v_mul_f32 v52, 1035273459, v52
    v_mul_f32 v56, 1035273459, v56
    v_mul_f32 v60, 1035273459, v60
    v_cvt_pk_bf16_f32 v32, v48, v52
    v_cvt_pk_bf16_f32 v33, v56, v60
    s_waitcnt vmcnt(31)
    v_mfma_f32_16x16x32_bf16 v[80:83], v[80:83], v[12:15], 0
    v_mfma_f32_16x16x32_bf16 v[84:87], v[84:87], v[12:15], 0
    v_mfma_f32_16x16x32_bf16 v[88:91], v[88:91], v[12:15], 0
    v_mfma_f32_16x16x32_bf16 v[92:95], v[92:95], v[12:15], 0
    v_mov_b32_dpp v64, v64 quad_perm:[0,0,0,0] row_mask:0xf bank_mask:0xf
    v_mov_b32_dpp v68, v68 quad_perm:[0,0,0,0] row_mask:0xf bank_mask:0xf
    v_mov_b32_dpp v72, v72 quad_perm:[0,0,0,0] row_mask:0xf bank_mask:0xf
    v_mov_b32_dpp v76, v76 quad_perm:[0,0,0,0] row_mask:0xf bank_mask:0xf
    v_add_f32_dpp v64, v65, v64 quad_perm:[1,1,1,1] row_mask:0xf bank_mask:0xf
    v_add_f32_dpp v68, v69, v68 quad_perm:[1,1,1,1] row_mask:0xf bank_mask:0xf
    v_add_f32_dpp v72, v73, v72 quad_perm:[1,1,1,1] row_mask:0xf bank_mask:0xf
    v_add_f32_dpp v76, v77, v76 quad_perm:[1,1,1,1] row_mask:0xf bank_mask:0xf
    v_add_f32_dpp v64, v66, v64 quad_perm:[2,2,2,2] row_mask:0xf bank_mask:0xf
    v_add_f32_dpp v68, v70, v68 quad_perm:[2,2,2,2] row_mask:0xf bank_mask:0xf
    v_add_f32_dpp v72, v74, v72 quad_perm:[2,2,2,2] row_mask:0xf bank_mask:0xf
    v_add_f32_dpp v76, v78, v76 quad_perm:[2,2,2,2] row_mask:0xf bank_mask:0xf
    v_add_f32_dpp v64, v67, v64 quad_perm:[3,3,3,3] row_mask:0xf bank_mask:0xf
    v_add_f32_dpp v68, v71, v68 quad_perm:[3,3,3,3] row_mask:0xf bank_mask:0xf
    v_add_f32_dpp v72, v75, v72 quad_perm:[3,3,3,3] row_mask:0xf bank_mask:0xf
    v_add_f32_dpp v76, v79, v76 quad_perm:[3,3,3,3] row_mask:0xf bank_mask:0xf
    v_max3_f32 v5, v5, v64, v68
    v_max3_f32 v5, v5, v72, v76
    v_cvt_pk_bf16_f32 v64, 0, v64
    v_cvt_pk_bf16_f32 v68, 0, v68
    v_cvt_pk_bf16_f32 v72, 0, v72
    v_cvt_pk_bf16_f32 v76, 0, v76
    v_mul_f32 v64, 1035273459, v64
    v_mul_f32 v68, 1035273459, v68
    v_mul_f32 v72, 1035273459, v72
    v_mul_f32 v76, 1035273459, v76
    v_cvt_pk_bf16_f32 v34, v64, v68
    v_cvt_pk_bf16_f32 v35, v72, v76
    s_cmp_gt_u32 s60, 0
    s_cbranch_scc1 L_thr0_v6
    s_waitcnt vmcnt(7)
L_thr0_v6:
    s_cmp_gt_u32 s60, 1
    s_cbranch_scc1 L_thr1_v6
    s_waitcnt vmcnt(8)
L_thr1_v6:
    s_mov_b32 s90, 49152
    buffer_load_dwordx4 v[200:203], v2, s[36:39], s90 offen offset:0 nt
    s_waitcnt vmcnt(28)
    v_mfma_f32_16x16x32_bf16 v[96:99], v[96:99], v[12:15], 0
    v_mfma_f32_16x16x32_bf16 v[100:103], v[100:103], v[12:15], 0
    v_mfma_f32_16x16x32_bf16 v[104:107], v[104:107], v[12:15], 0
    v_mfma_f32_16x16x32_bf16 v[108:111], v[108:111], v[12:15], 0
    v_mov_b32_dpp v80, v80 quad_perm:[0,0,0,0] row_mask:0xf bank_mask:0xf
    v_mov_b32_dpp v84, v84 quad_perm:[0,0,0,0] row_mask:0xf bank_mask:0xf
    v_mov_b32_dpp v88, v88 quad_perm:[0,0,0,0] row_mask:0xf bank_mask:0xf
    v_mov_b32_dpp v92, v92 quad_perm:[0,0,0,0] row_mask:0xf bank_mask:0xf
    v_add_f32_dpp v80, v81, v80 quad_perm:[1,1,1,1] row_mask:0xf bank_mask:0xf
    v_add_f32_dpp v84, v85, v84 quad_perm:[1,1,1,1] row_mask:0xf bank_mask:0xf
    v_add_f32_dpp v88, v89, v88 quad_perm:[1,1,1,1] row_mask:0xf bank_mask:0xf
    v_add_f32_dpp v92, v93, v92 quad_perm:[1,1,1,1] row_mask:0xf bank_mask:0xf
    v_add_f32_dpp v80, v82, v80 quad_perm:[2,2,2,2] row_mask:0xf bank_mask:0xf
    v_add_f32_dpp v84, v86, v84 quad_perm:[2,2,2,2] row_mask:0xf bank_mask:0xf
    v_add_f32_dpp v88, v90, v88 quad_perm:[2,2,2,2] row_mask:0xf bank_mask:0xf
    v_add_f32_dpp v92, v94, v92 quad_perm:[2,2,2,2] row_mask:0xf bank_mask:0xf
    v_add_f32_dpp v80, v83, v80 quad_perm:[3,3,3,3] row_mask:0xf bank_mask:0xf
    v_add_f32_dpp v84, v87, v84 quad_perm:[3,3,3,3] row_mask:0xf bank_mask:0xf
    v_add_f32_dpp v88, v91, v88 quad_perm:[3,3,3,3] row_mask:0xf bank_mask:0xf
    v_add_f32_dpp v92, v95, v92 quad_perm:[3,3,3,3] row_mask:0xf bank_mask:0xf
    v_max3_f32 v5, v5, v80, v84
    v_max3_f32 v5, v5, v88, v92
    v_cvt_pk_bf16_f32 v80, 0, v80
    v_cvt_pk_bf16_f32 v84, 0, v84
    v_cvt_pk_bf16_f32 v88, 0, v88
    v_cvt_pk_bf16_f32 v92, 0, v92
    v_mul_f32 v80, 1035273459, v80
    v_mul_f32 v84, 1035273459, v84
    v_mul_f32 v88, 1035273459, v88
    v_mul_f32 v92, 1035273459, v92
    v_cvt_pk_bf16_f32 v36, v80, v84
    v_cvt_pk_bf16_f32 v37, v88, v92
    s_waitcnt vmcnt(24)
    v_mfma_f32_16x16x32_bf16 v[112:115], v[112:115], v[12:15], 0
    v_mfma_f32_16x16x32_bf16 v[116:119], v[116:119], v[12:15], 0
    v_mfma_f32_16x16x32_bf16 v[120:123], v[120:123], v[12:15], 0
    v_mfma_f32_16x16x32_bf16 v[124:127], v[124:127], v[12:15], 0
    v_mov_b32_dpp v96, v96 quad_perm:[0,0,0,0] row_mask:0xf bank_mask:0xf
    v_mov_b32_dpp v100, v100 quad_perm:[0,0,0,0] row_mask:0xf bank_mask:0xf
    v_mov_b32_dpp v104, v104 quad_perm:[0,0,0,0] row_mask:0xf bank_mask:0xf
    v_mov_b32_dpp v108, v108 quad_perm:[0,0,0,0] row_mask:0xf bank_mask:0xf
    v_add_f32_dpp v96, v97, v96 quad_perm:[1,1,1,1] row_mask:0xf bank_mask:0xf
    v_add_f32_dpp v100, v101, v100 quad_perm:[1,1,1,1] row_mask:0xf bank_mask:0xf
    v_add_f32_dpp v104, v105, v104 quad_perm:[1,1,1,1] row_mask:0xf bank_mask:0xf
    v_add_f32_dpp v108, v109, v108 quad_perm:[1,1,1,1] row_mask:0xf bank_mask:0xf
    v_add_f32_dpp v96, v98, v96 quad_perm:[2,2,2,2] row_mask:0xf bank_mask:0xf
    v_add_f32_dpp v100, v102, v100 quad_perm:[2,2,2,2] row_mask:0xf bank_mask:0xf
    v_add_f32_dpp v104, v106, v104 quad_perm:[2,2,2,2] row_mask:0xf bank_mask:0xf
    v_add_f32_dpp v108, v110, v108 quad_perm:[2,2,2,2] row_mask:0xf bank_mask:0xf
    v_add_f32_dpp v96, v99, v96 quad_perm:[3,3,3,3] row_mask:0xf bank_mask:0xf
    v_add_f32_dpp v100, v103, v100 quad_perm:[3,3,3,3] row_mask:0xf bank_mask:0xf
    v_add_f32_dpp v104, v107, v104 quad_perm:[3,3,3,3] row_mask:0xf bank_mask:0xf
    v_add_f32_dpp v108, v111, v108 quad_perm:[3,3,3,3] row_mask:0xf bank_mask:0xf
    v_max3_f32 v5, v5, v96, v100
    v_max3_f32 v5, v5, v104, v108
    v_cvt_pk_bf16_f32 v96, 0, v96
    v_cvt_pk_bf16_f32 v100, 0, v100
    v_cvt_pk_bf16_f32 v104, 0, v104
    v_cvt_pk_bf16_f32 v108, 0, v108
    v_mul_f32 v96, 1035273459, v96
    v_mul_f32 v100, 1035273459, v100
    v_mul_f32 v104, 1035273459, v104
    v_mul_f32 v108, 1035273459, v108
    v_cvt_pk_bf16_f32 v38, v96, v100
    v_cvt_pk_bf16_f32 v39, v104, v108
    s_cmp_gt_u32 s60, 0
    s_cbranch_scc1 L_thr0_v7
    s_waitcnt vmcnt(2)
L_thr0_v7:
    s_cmp_gt_u32 s60, 1
    s_cbranch_scc1 L_thr1_v7
    s_waitcnt vmcnt(8)
L_thr1_v7:
    s_mov_b32 s90, 57344
    buffer_load_dwordx4 v[204:207], v2, s[36:39], s90 offen offset:0 nt
    s_waitcnt vmcnt(21)
    v_mfma_f32_16x16x32_bf16 v[128:131], v[128:131], v[12:15], 0
    v_mfma_f32_16x16x32_bf16 v[132:135], v[132:135], v[12:15], 0
    v_mfma_f32_16x16x32_bf16 v[136:139], v[136:139], v[12:15], 0
    v_mfma_f32_16x16x32_bf16 v[140:143], v[140:143], v[12:15], 0
    v_mov_b32_dpp v112, v112 quad_perm:[0,0,0,0] row_mask:0xf bank_mask:0xf
    v_mov_b32_dpp v116, v116 quad_perm:[0,0,0,0] row_mask:0xf bank_mask:0xf
    v_mov_b32_dpp v120, v120 quad_perm:[0,0,0,0] row_mask:0xf bank_mask:0xf
    v_mov_b32_dpp v124, v124 quad_perm:[0,0,0,0] row_mask:0xf bank_mask:0xf
    v_add_f32_dpp v112, v113, v112 quad_perm:[1,1,1,1] row_mask:0xf bank_mask:0xf
    v_add_f32_dpp v116, v117, v116 quad_perm:[1,1,1,1] row_mask:0xf bank_mask:0xf
    v_add_f32_dpp v120, v121, v120 quad_perm:[1,1,1,1] row_mask:0xf bank_mask:0xf
    v_add_f32_dpp v124, v125, v124 quad_perm:[1,1,1,1] row_mask:0xf bank_mask:0xf
    v_add_f32_dpp v112, v114, v112 quad_perm:[2,2,2,2] row_mask:0xf bank_mask:0xf
    v_add_f32_dpp v116, v118, v116 quad_perm:[2,2,2,2] row_mask:0xf bank_mask:0xf
    v_add_f32_dpp v120, v122, v120 quad_perm:[2,2,2,2] row_mask:0xf bank_mask:0xf
    v_add_f32_dpp v124, v126, v124 quad_perm:[2,2,2,2] row_mask:0xf bank_mask:0xf
    v_add_f32_dpp v112, v115, v112 quad_perm:[3,3,3,3] row_mask:0xf bank_mask:0xf
    v_add_f32_dpp v116, v119, v116 quad_perm:[3,3,3,3] row_mask:0xf bank_mask:0xf
    v_add_f32_dpp v120, v123, v120 quad_perm:[3,3,3,3] row_mask:0xf bank_mask:0xf
    v_add_f32_dpp v124, v127, v124 quad_perm:[3,3,3,3] row_mask:0xf bank_mask:0xf
    v_max3_f32 v5, v5, v112, v116
    v_max3_f32 v5, v5, v120, v124
    v_cvt_pk_bf16_f32 v112, 0, v112
    v_cvt_pk_bf16_f32 v116, 0, v116
    v_cvt_pk_bf16_f32 v120, 0, v120
    v_cvt_pk_bf16_f32 v124, 0, v124
    v_mul_f32 v112, 1035273459, v112
    v_mul_f32 v116, 1035273459, v116
    v_mul_f32 v120, 1035273459, v120
    v_mul_f32 v124, 1035273459, v124
    v_cvt_pk_bf16_f32 v40, v112, v116
    v_cvt_pk_bf16_f32 v41, v120, v124
    s_waitcnt vmcnt(17)
    v_mfma_f32_16x16x32_bf16 v[144:147], v[144:147], v[12:15], 0
    v_mfma_f32_16x16x32_bf16 v[148:151], v[148:151], v[12:15], 0
    v_mfma_f32_16x16x32_bf16 v[152:155], v[152:155], v[12:15], 0
    v_mfma_f32_16x16x32_bf16 v[156:159], v[156:159], v[12:15], 0
    v_mov_b32_dpp v128, v128 quad_perm:[0,0,0,0] row_mask:0xf bank_mask:0xf
    v_mov_b32_dpp v132, v132 quad_perm:[0,0,0,0] row_mask:0xf bank_mask:0xf
    v_mov_b32_dpp v136, v136 quad_perm:[0,0,0,0] row_mask:0xf bank_mask:0xf
    v_mov_b32_dpp v140, v140 quad_perm:[0,0,0,0] row_mask:0xf bank_mask:0xf
    v_add_f32_dpp v128, v129, v128 quad_perm:[1,1,1,1] row_mask:0xf bank_mask:0xf
    v_add_f32_dpp v132, v133, v132 quad_perm:[1,1,1,1] row_mask:0xf bank_mask:0xf
    v_add_f32_dpp v136, v137, v136 quad_perm:[1,1,1,1] row_mask:0xf bank_mask:0xf
    v_add_f32_dpp v140, v141, v140 quad_perm:[1,1,1,1] row_mask:0xf bank_mask:0xf
    v_add_f32_dpp v128, v130, v128 quad_perm:[2,2,2,2] row_mask:0xf bank_mask:0xf
    v_add_f32_dpp v132, v134, v132 quad_perm:[2,2,2,2] row_mask:0xf bank_mask:0xf
    v_add_f32_dpp v136, v138, v136 quad_perm:[2,2,2,2] row_mask:0xf bank_mask:0xf
    v_add_f32_dpp v140, v142, v140 quad_perm:[2,2,2,2] row_mask:0xf bank_mask:0xf
    v_add_f32_dpp v128, v131, v128 quad_perm:[3,3,3,3] row_mask:0xf bank_mask:0xf
    v_add_f32_dpp v132, v135, v132 quad_perm:[3,3,3,3] row_mask:0xf bank_mask:0xf
    v_add_f32_dpp v136, v139, v136 quad_perm:[3,3,3,3] row_mask:0xf bank_mask:0xf
    v_add_f32_dpp v140, v143, v140 quad_perm:[3,3,3,3] row_mask:0xf bank_mask:0xf
    v_max3_f32 v5, v5, v128, v132
    v_max3_f32 v5, v5, v136, v140
    v_cvt_pk_bf16_f32 v128, 0, v128
    v_cvt_pk_bf16_f32 v132, 0, v132
    v_cvt_pk_bf16_f32 v136, 0, v136
    v_cvt_pk_bf16_f32 v140, 0, v140
    v_mul_f32 v128, 1035273459, v128
    v_mul_f32 v132, 1035273459, v132
    v_mul_f32 v136, 1035273459, v136
    v_mul_f32 v140, 1035273459, v140
    v_cvt_pk_bf16_f32 v42, v128, v132
    v_cvt_pk_bf16_f32 v43, v136, v140
    s_cmp_gt_u32 s60, 0
    s_cbranch_scc1 L_thr0_v8
    s_waitcnt vmcnt(2)
L_thr0_v8:
    s_cmp_gt_u32 s60, 1
    s_cbranch_scc1 L_thr1_v8
    s_waitcnt vmcnt(3)
L_thr1_v8:
    s_waitcnt vmcnt(12)
    s_setprio 2
    s_mov_b32 s90, 65536
    buffer_load_dwordx4 v[208:211], v2, s[36:39], s90 offen offset:0 nt
    v_mfma_f32_16x16x32_bf16 v[160:163], v[160:163], v[12:15], 0
    v_mfma_f32_16x16x32_bf16 v[164:167], v[164:167], v[12:15], 0
    v_mfma_f32_16x16x32_bf16 v[168:171], v[168:171], v[12:15], 0
    v_mfma_f32_16x16x32_bf16 v[172:175], v[172:175], v[12:15], 0
    v_mov_b32_dpp v144, v144 quad_perm:[0,0,0,0] row_mask:0xf bank_mask:0xf
    v_mov_b32_dpp v148, v148 quad_perm:[0,0,0,0] row_mask:0xf bank_mask:0xf
    v_mov_b32_dpp v152, v152 quad_perm:[0,0,0,0] row_mask:0xf bank_mask:0xf
    v_mov_b32_dpp v156, v156 quad_perm:[0,0,0,0] row_mask:0xf bank_mask:0xf
    v_add_f32_dpp v144, v145, v144 quad_perm:[1,1,1,1] row_mask:0xf bank_mask:0xf
    v_add_f32_dpp v148, v149, v148 quad_perm:[1,1,1,1] row_mask:0xf bank_mask:0xf
    v_add_f32_dpp v152, v153, v152 quad_perm:[1,1,1,1] row_mask:0xf bank_mask:0xf
    v_add_f32_dpp v156, v157, v156 quad_perm:[1,1,1,1] row_mask:0xf bank_mask:0xf
    v_add_f32_dpp v144, v146, v144 quad_perm:[2,2,2,2] row_mask:0xf bank_mask:0xf
    v_add_f32_dpp v148, v150, v148 quad_perm:[2,2,2,2] row_mask:0xf bank_mask:0xf
    v_add_f32_dpp v152, v154, v152 quad_perm:[2,2,2,2] row_mask:0xf bank_mask:0xf
    v_add_f32_dpp v156, v158, v156 quad_perm:[2,2,2,2] row_mask:0xf bank_mask:0xf
    v_add_f32_dpp v144, v147, v144 quad_perm:[3,3,3,3] row_mask:0xf bank_mask:0xf
    v_add_f32_dpp v148, v151, v148 quad_perm:[3,3,3,3] row_mask:0xf bank_mask:0xf
    v_add_f32_dpp v152, v155, v152 quad_perm:[3,3,3,3] row_mask:0xf bank_mask:0xf
    v_add_f32_dpp v156, v159, v156 quad_perm:[3,3,3,3] row_mask:0xf bank_mask:0xf
    v_max3_f32 v5, v5, v144, v148
    v_max3_f32 v5, v5, v152, v156
    v_cvt_pk_bf16_f32 v144, 0, v144
    v_cvt_pk_bf16_f32 v148, 0, v148
    v_cvt_pk_bf16_f32 v152, 0, v152
    v_cvt_pk_bf16_f32 v156, 0, v156
    v_mul_f32 v144, 1035273459, v144
    v_mul_f32 v148, 1035273459, v148
    v_mul_f32 v152, 1035273459, v152
    v_mul_f32 v156, 1035273459, v156
    v_cvt_pk_bf16_f32 v44, v144, v148
    v_cvt_pk_bf16_f32 v45, v152, v156
    v_mov_b32_dpp v160, v160 quad_perm:[0,0,0,0] row_mask:0xf bank_mask:0xf
    v_mov_b32_dpp v164, v164 quad_perm:[0,0,0,0] row_mask:0xf bank_mask:0xf
    v_mov_b32_dpp v168, v168 quad_perm:[0,0,0,0] row_mask:0xf bank_mask:0xf
    v_mov_b32_dpp v172, v172 quad_perm:[0,0,0,0] row_mask:0xf bank_mask:0xf
    v_add_f32_dpp v160, v161, v160 quad_perm:[1,1,1,1] row_mask:0xf bank_mask:0xf
    v_add_f32_dpp v164, v165, v164 quad_perm:[1,1,1,1] row_mask:0xf bank_mask:0xf
    v_add_f32_dpp v168, v169, v168 quad_perm:[1,1,1,1] row_mask:0xf bank_mask:0xf
    v_add_f32_dpp v172, v173, v172 quad_perm:[1,1,1,1] row_mask:0xf bank_mask:0xf
    v_add_f32_dpp v160, v162, v160 quad_perm:[2,2,2,2] row_mask:0xf bank_mask:0xf
    v_add_f32_dpp v164, v166, v164 quad_perm:[2,2,2,2] row_mask:0xf bank_mask:0xf
    v_add_f32_dpp v168, v170, v168 quad_perm:[2,2,2,2] row_mask:0xf bank_mask:0xf
    v_add_f32_dpp v172, v174, v172 quad_perm:[2,2,2,2] row_mask:0xf bank_mask:0xf
    v_add_f32_dpp v160, v163, v160 quad_perm:[3,3,3,3] row_mask:0xf bank_mask:0xf
    v_add_f32_dpp v164, v167, v164 quad_perm:[3,3,3,3] row_mask:0xf bank_mask:0xf
    v_add_f32_dpp v168, v171, v168 quad_perm:[3,3,3,3] row_mask:0xf bank_mask:0xf
    v_add_f32_dpp v172, v175, v172 quad_perm:[3,3,3,3] row_mask:0xf bank_mask:0xf
    v_max3_f32 v5, v5, v160, v164
    v_max3_f32 v5, v5, v168, v172
    v_cvt_pk_bf16_f32 v160, 0, v160
    v_cvt_pk_bf16_f32 v164, 0, v164
    v_cvt_pk_bf16_f32 v168, 0, v168
    v_cvt_pk_bf16_f32 v172, 0, v172
    v_mul_f32 v160, 1035273459, v160
    v_mul_f32 v164, 1035273459, v164
    v_mul_f32 v168, 1035273459, v168
    v_mul_f32 v172, 1035273459, v172
    v_cvt_pk_bf16_f32 v46, v160, v164
    v_cvt_pk_bf16_f32 v47, v168, v172
    s_cmp_gt_u32 s60, 0
    s_cbranch_scc1 L_thr0_v9
    s_waitcnt vmcnt(2)
L_thr0_v9:
    s_cmp_gt_u32 s60, 1
    s_cbranch_scc1 L_thr1_v9
    s_waitcnt vmcnt(3)
L_thr1_v9:
    s_waitcnt vmcnt(12)
    s_mov_b32 s90, 73728
    buffer_load_dwordx4 v[212:215], v2, s[36:39], s90 offen offset:0 nt
    s_waitcnt vmcnt(6)
    s_mov_b32 s91, 400015
    v_xor_b32 v240, s85, v240
    v_xor_b32 v241, s86, v241
    v_xor_b32 v242, s87, v242
    v_xor_b32 v243, s88, v243
    v_or3_b32 v31, v240, v241, v242
    v_or_b32 v31, v31, v243
    v_xor_b32 v244, s85, v244
    v_xor_b32 v245, s86, v245
    v_xor_b32 v246, s87, v246
    v_xor_b32 v247, s88, v247
    v_or3_b32 v31, v31, v244, v245
    v_or3_b32 v31, v31, v246, v247
    v_xor_b32 v248, s85, v248
    v_xor_b32 v249, s86, v249
    v_xor_b32 v250, s87, v250
    v_xor_b32 v251, s88, v251
    v_or3_b32 v31, v31, v248, v249
    v_or3_b32 v31, v31, v250, v251
    v_xor_b32 v252, s85, v252
    v_xor_b32 v253, s86, v253
    v_xor_b32 v254, s87, v254
    v_xor_b32 v255, s88, v255
    v_or3_b32 v31, v31, v252, v253
    v_or3_b32 v31, v31, v254, v255
    v_and_b32 v31, 0xff, v31
    v_cmp_ne_u32 vcc, 0, v31
    s_cbranch_vccz L_ok_14
L_poll_13:
    buffer_load_dwordx4 v[240:243], v3, s[40:43], 0 offen offset:0 sc1
    s_mov_b32 s90, 4096
    buffer_load_dwordx4 v[244:247], v3, s[40:43], s90 offen offset:0 sc1
    buffer_load_dwordx4 v[248:251], v3, s[40:43], 0 offen offset:2048 sc1
    s_mov_b32 s90, 4096
    buffer_load_dwordx4 v[252:255], v4, s[40:43], s90 offen offset:2048 sc1
    s_waitcnt vmcnt(0)
    v_xor_b32 v240, s85, v240
    v_xor_b32 v241, s86, v241
    v_xor_b32 v242, s87, v242
    v_xor_b32 v243, s88, v243
    v_or3_b32 v31, v240, v241, v242
    v_or_b32 v31, v31, v243
    v_xor_b32 v244, s85, v244
    v_xor_b32 v245, s86, v245
    v_xor_b32 v246, s87, v246
    v_xor_b32 v247, s88, v247
    v_or3_b32 v31, v31, v244, v245
    v_or3_b32 v31, v31, v246, v247
    v_xor_b32 v248, s85, v248
    v_xor_b32 v249, s86, v249
    v_xor_b32 v250, s87, v250
    v_xor_b32 v251, s88, v251
    v_or3_b32 v31, v31, v248, v249
    v_or3_b32 v31, v31, v250, v251
    v_xor_b32 v252, s85, v252
    v_xor_b32 v253, s86, v253
    v_xor_b32 v254, s87, v254
    v_xor_b32 v255, s88, v255
    v_or3_b32 v31, v31, v252, v253
    v_or3_b32 v31, v31, v254, v255
    v_and_b32 v31, 0xff, v31
    v_cmp_ne_u32 vcc, 0, v31
    s_cbranch_vccz L_done_15
    s_sub_u32 s91, s91, 1
    s_cbranch_scc0 L_poll_13
L_done_15:
L_ok_14:
    s_nop 1
    s_mov_b64 exec, 0xffff
    v_mov_b32 v25, v240
    v_add_f32 v26, 1.0, v244
    v_mov_b32 v27, v248
    v_mov_b32 v28, v252
    s_lshl_b64 exec, exec, 16
    v_mov_b32 v25, v241
    v_add_f32 v26, 1.0, v245
    v_mov_b32 v27, v249
    v_mov_b32 v28, v253
    s_lshl_b64 exec, exec, 16
    v_mov_b32 v25, v242
    v_add_f32 v26, 1.0, v246
    v_mov_b32 v27, v250
    v_mov_b32 v28, v254
    s_lshl_b64 exec, exec, 16
    v_mov_b32 v25, v243
    v_add_f32 v26, 1.0, v247
    v_mov_b32 v27, v251
    v_mov_b32 v28, v255
    s_mov_b64 exec, -1
    v_cvt_pk_bf16_f32 v26, 0, v26
    v_lshlrev_b32 v24, 16, v24
    v_lshrrev_b32 v31, 4, v0
    v_and_b32 v29, 15, v0
    s_lshl_b32 s95, s84, 7
    v_lshlrev_b32 v4, 13, v31
    v_lshl_add_u32 v4, v29, 3, v4
    v_add_u32 v4, s95, v4
    v_mov_b32 v31, v5
    s_nop 1
    v_permlane16_swap_b32 v31, v5
    v_max_f32 v5, v5, v31
    v_mov_b32 v31, v5
    s_nop 1
    v_permlane32_swap_b32 v31, v5
    v_max_f32 v5, v5, v31
    v_cvt_pk_bf16_f32 v5, 0, v5
    v_mul_f32 v5, 1035273459, v5
    v_cvt_pk_bf16_f32 v5, 0, v5
    v_mul_f32 v31, 0xbfb8aa3b, v5
    v_mov_b32 v6, 0
    v_lshlrev_b32 v160, 16, v32
    v_and_b32 v161, 0xffff0000, v32
    v_lshlrev_b32 v162, 16, v33
    v_and_b32 v163, 0xffff0000, v33
    v_lshlrev_b32 v164, 16, v34
    v_and_b32 v165, 0xffff0000, v34
    v_lshlrev_b32 v166, 16, v35
    v_and_b32 v167, 0xffff0000, v35
    v_fma_f32 v160, v160, s94, v31
    v_fma_f32 v161, v161, s94, v31
    v_fma_f32 v162, v162, s94, v31
    v_fma_f32 v163, v163, s94, v31
    v_fma_f32 v164, v164, s94, v31
    v_fma_f32 v165, v165, s94, v31
    v_fma_f32 v166, v166, s94, v31
    v_fma_f32 v167, v167, s94, v31
    v_exp_f32 v160, v160
    v_exp_f32 v161, v161
    v_exp_f32 v162, v162
    v_exp_f32 v163, v163
    v_exp_f32 v164, v164
    v_exp_f32 v165, v165
    v_exp_f32 v166, v166
    v_exp_f32 v167, v167
    v_cvt_pk_bf16_f32 v32, v160, v161
    v_cvt_pk_bf16_f32 v33, v162, v163
    v_cvt_pk_bf16_f32 v34, v164, v165
    v_cvt_pk_bf16_f32 v35, v166, v167
    v_add_f32 v160, v160, v161
    v_add_f32 v162, v162, v163
    v_add_f32 v164, v164, v165
    v_add_f32 v166, v166, v167
    v_add_f32 v160, v160, v162
    v_add_f32 v164, v164, v166
    v_add_f32 v160, v160, v164
    v_add_f32 v6, v6, v160
    s_cmp_gt_u32 s60, 0
    s_cbranch_scc1 L_thr0_v10
    s_waitcnt vmcnt(2)
L_thr0_v10:
    s_cmp_gt_u32 s60, 1
    s_cbranch_scc1 L_thr1_v10
    s_waitcnt vmcnt(3)
L_thr1_v10:
    s_mov_b32 s90, 81920
    buffer_load_dwordx4 v[216:219], v2, s[36:39], s90 offen offset:0 nt
    v_lshlrev_b32 v160, 16, v36
    v_and_b32 v161, 0xffff0000, v36
    v_lshlrev_b32 v162, 16, v37
    v_and_b32 v163, 0xffff0000, v37
    v_lshlrev_b32 v164, 16, v38
    v_and_b32 v165, 0xffff0000, v38
    v_lshlrev_b32 v166, 16, v39
    v_and_b32 v167, 0xffff0000, v39
    v_fma_f32 v160, v160, s94, v31
    v_fma_f32 v161, v161, s94, v31
    v_fma_f32 v162, v162, s94, v31
    v_fma_f32 v163, v163, s94, v31
    v_fma_f32 v164, v164, s94, v31
    v_fma_f32 v165, v165, s94, v31
    v_fma_f32 v166, v166, s94, v31
    v_fma_f32 v167, v167, s94, v31
    v_exp_f32 v160, v160
    v_exp_f32 v161, v161
    v_exp_f32 v162, v162
    v_exp_f32 v163, v163
    v_exp_f32 v164, v164
    v_exp_f32 v165, v165
    v_exp_f32 v166, v166
    v_exp_f32 v167, v167
    v_cvt_pk_bf16_f32 v36, v160, v161
    v_cvt_pk_bf16_f32 v37, v162, v163
    v_cvt_pk_bf16_f32 v38, v164, v165
    v_cvt_pk_bf16_f32 v39, v166, v167
    v_add_f32 v160, v160, v161
    v_add_f32 v162, v162, v163
    v_add_f32 v164, v164, v165
    v_add_f32 v166, v166, v167
    v_add_f32 v160, v160, v162
    v_add_f32 v164, v164, v166
    v_add_f32 v160, v160, v164
    v_add_f32 v6, v6, v160
    v_lshlrev_b32 v160, 16, v40
    v_and_b32 v161, 0xffff0000, v40
    v_lshlrev_b32 v162, 16, v41
    v_and_b32 v163, 0xffff0000, v41
    v_lshlrev_b32 v164, 16, v42
    v_and_b32 v165, 0xffff0000, v42
    v_lshlrev_b32 v166, 16, v43
    v_and_b32 v167, 0xffff0000, v43
    v_fma_f32 v160, v160, s94, v31
    v_fma_f32 v161, v161, s94, v31
    v_fma_f32 v162, v162, s94, v31
    v_fma_f32 v163, v163, s94, v31
    v_fma_f32 v164, v164, s94, v31
    v_fma_f32 v165, v165, s94, v31
    v_fma_f32 v166, v166, s94, v31
    v_fma_f32 v167, v167, s94, v31
    v_exp_f32 v160, v160
    v_exp_f32 v161, v161
    v_exp_f32 v162, v162
    v_exp_f32 v163, v163
    v_exp_f32 v164, v164
    v_exp_f32 v165, v165
    v_exp_f32 v166, v166
    v_exp_f32 v167, v167
    v_cvt_pk_bf16_f32 v40, v160, v161
    v_cvt_pk_bf16_f32 v41, v162, v163
    v_cvt_pk_bf16_f32 v42, v164, v165
    v_cvt_pk_bf16_f32 v43, v166, v167
    v_add_f32 v160, v160, v161
    v_add_f32 v162, v162, v163
    v_add_f32 v164, v164, v165
    v_add_f32 v166, v166, v167
    v_add_f32 v160, v160, v162
    v_add_f32 v164, v164, v166
    v_add_f32 v160, v160, v164
    v_add_f32 v6, v6, v160
    s_cmp_gt_u32 s60, 0
    s_cbranch_scc1 L_thr0_v11
    s_waitcnt vmcnt(2)
L_thr0_v11:
    s_cmp_gt_u32 s60, 1
    s_cbranch_scc1 L_thr1_v11
    s_waitcnt vmcnt(3)
L_thr1_v11:
    s_mov_b32 s90, 90112
    buffer_load_dwordx4 v[220:223], v2, s[36:39], s90 offen offset:0 nt
    v_lshlrev_b32 v160, 16, v44
    v_and_b32 v161, 0xffff0000, v44
    v_lshlrev_b32 v162, 16, v45
    v_and_b32 v163, 0xffff0000, v45
    v_lshlrev_b32 v164, 16, v46
    v_and_b32 v165, 0xffff0000, v46
    v_lshlrev_b32 v166, 16, v47
    v_and_b32 v167, 0xffff0000, v47
    v_fma_f32 v160, v160, s94, v31
    v_fma_f32 v161, v161, s94, v31
    v_fma_f32 v162, v162, s94, v31
    v_fma_f32 v163, v163, s94, v31
    v_fma_f32 v164, v164, s94, v31
    v_fma_f32 v165, v165, s94, v31
    v_fma_f32 v166, v166, s94, v31
    v_fma_f32 v167, v167, s94, v31
    v_exp_f32 v160, v160
    v_exp_f32 v161, v161
    v_exp_f32 v162, v162
    v_exp_f32 v163, v163
    v_exp_f32 v164, v164
    v_exp_f32 v165, v165
    v_exp_f32 v166, v166
    v_exp_f32 v167, v167
    v_cvt_pk_bf16_f32 v44, v160, v161
    v_cvt_pk_bf16_f32 v45, v162, v163
    v_cvt_pk_bf16_f32 v46, v164, v165
    v_cvt_pk_bf16_f32 v47, v166, v167
    v_add_f32 v160, v160, v161
    v_add_f32 v162, v162, v163
    v_add_f32 v164, v164, v165
    v_add_f32 v166, v166, v167
    v_add_f32 v160, v160, v162
    v_add_f32 v164, v164, v166
    v_add_f32 v160, v160, v164
    v_add_f32 v6, v6, v160
    v_mov_b32 v31, v6
    s_nop 1
    v_permlane16_swap_b32 v31, v6
    v_add_f32 v6, v6, v31
    v_mov_b32 v31, v6
    s_nop 1
    v_permlane32_swap_b32 v31, v6
    v_add_f32 v6, v6, v31
    v_bfe_u32 v31, v0, 2, 2
    v_lshlrev_b32 v31, 5, v31
    s_lshl_b32 s95, s84, 2
    v_add_u32 v31, s95, v31
    v_mov_b32 v29, 0
    v_mov_b32 v30, 1
    s_mov_b64 exec, 0x1111
    ds_write_b32 v31, v5 offset:1152
    ds_write_b32 v31, v6 offset:1280
    s_mov_b64 exec, 1
    ds_add_u32 v29, v30 offset:1032
    s_mov_b64 exec, -1
    v_perm_b32 v12, v32, v32, v8
    v_perm_b32 v13, v32, v32, v9
    s_nop 1
    v_mfma_f32_16x16x16_bf16 v[16:19], v[12:13], v[176:177], 0
    v_mfma_f32_16x16x16_bf16 v[20:23], v[12:13], v[178:179], 0
    v_perm_b32 v14, v32, v32, v10
    v_perm_b32 v15, v32, v32, v11
    s_nop 1
    v_mfma_f32_16x16x16_bf16 v[16:19], v[14:15], v[180:181], v[16:19]
    v_mfma_f32_16x16x16_bf16 v[20:23], v[14:15], v[182:183], v[20:23]
    v_perm_b32 v12, v33, v33, v8
    v_perm_b32 v13, v33, v33, v9
    s_nop 1
    v_mfma_f32_16x16x16_bf16 v[16:19], v[12:13], v[184:185], v[16:19]
    v_mfma_f32_16x16x16_bf16 v[20:23], v[12:13], v[186:187], v[20:23]
    v_perm_b32 v14, v33, v33, v10
    v_perm_b32 v15, v33, v33, v11
    s_nop 1
    v_mfma_f32_16x16x16_bf16 v[16:19], v[14:15], v[188:189], v[16:19]
    v_mfma_f32_16x16x16_bf16 v[20:23], v[14:15], v[190:191], v[20:23]
    v_perm_b32 v12, v34, v34, v8
    v_perm_b32 v13, v34, v34, v9
    s_waitcnt vmcnt(7)
    s_nop 0
    v_mfma_f32_16x16x16_bf16 v[16:19], v[12:13], v[192:193], v[16:19]
    v_mfma_f32_16x16x16_bf16 v[20:23], v[12:13], v[194:195], v[20:23]
    v_perm_b32 v14, v34, v34, v10
    v_perm_b32 v15, v34, v34, v11
    s_waitcnt vmcnt(6)
    s_nop 0
    v_mfma_f32_16x16x16_bf16 v[16:19], v[14:15], v[196:197], v[16:19]
    v_mfma_f32_16x16x16_bf16 v[20:23], v[14:15], v[198:199], v[20:23]
    v_perm_b32 v12, v35, v35, v8
    v_perm_b32 v13, v35, v35, v9
    s_waitcnt vmcnt(5)
    s_nop 0
    v_mfma_f32_16x16x16_bf16 v[16:19], v[12:13], v[200:201], v[16:19]
    v_mfma_f32_16x16x16_bf16 v[20:23], v[12:13], v[202:203], v[20:23]
    v_perm_b32 v14, v35, v35, v10
    v_perm_b32 v15, v35, v35, v11
    s_waitcnt vmcnt(4)
    s_nop 0
    v_mfma_f32_16x16x16_bf16 v[16:19], v[14:15], v[204:205], v[16:19]
    v_mfma_f32_16x16x16_bf16 v[20:23], v[14:15], v[206:207], v[20:23]
    s_cmp_gt_u32 s60, 0
    s_cbranch_scc1 L_thr0_v12
    s_waitcnt vmcnt(2)
L_thr0_v12:
    s_cmp_gt_u32 s60, 1
    s_cbranch_scc1 L_thr1_v12
    s_waitcnt vmcnt(3)
L_thr1_v12:
    s_mov_b32 s90, 98304
    buffer_load_dwordx4 v[224:227], v2, s[36:39], s90 offen offset:0 nt
    buffer_load_dwordx2 v[176:177], v4, s[52:55], 0 offen offset:0
    v_lshrrev_b32 v161, 4, v0
    v_bfe_u32 v162, v0, 2, 2
    v_lshl_add_u32 v160, v161, 3, v162
    v_lshlrev_b32 v160, 7, v160
    v_and_b32 v161, 1, v161
    v_lshl_add_u32 v160, v161, 6, v160
    v_lshrrev_b32 v162, 1, v162
    v_lshl_add_u32 v160, v162, 5, v160
    v_and_b32 v161, 3, v0
    v_lshl_add_u32 v160, v161, 3, v160
    v_add_u32 v160, s100, v160
    v_xor_b32 v161, 32, v160
    v_xor_b32 v162, 64, v160
    v_xor_b32 v163, 96, v160
    ds_read_b64_tr_b16 v[96:97], v160 offset:0
    ds_read_b64_tr_b16 v[98:99], v160 offset:512
    ds_read_b64_tr_b16 v[100:101], v161 offset:0
    ds_read_b64_tr_b16 v[102:103], v161 offset:512
    ds_read_b64_tr_b16 v[104:105], v162 offset:0
    ds_read_b64_tr_b16 v[106:107], v162 offset:512
    ds_read_b64_tr_b16 v[108:109], v163 offset:0
    ds_read_b64_tr_b16 v[110:111], v163 offset:512
    s_waitcnt lgkmcnt(7)
    ds_read_b64_tr_b16 v[112:113], v160 offset:4096
    ds_read_b64_tr_b16 v[114:115], v160 offset:4608
    ds_read_b64_tr_b16 v[116:117], v161 offset:4096
    ds_read_b64_tr_b16 v[118:119], v161 offset:4608
    ds_read_b64_tr_b16 v[120:121], v162 offset:4096
    ds_read_b64_tr_b16 v[122:123], v162 offset:4608
    ds_read_b64_tr_b16 v[124:125], v163 offset:4096
    ds_read_b64_tr_b16 v[126:127], v163 offset:4608
    s_waitcnt lgkmcnt(7)
    ds_read_b64_tr_b16 v[128:129], v160 offset:8192
    ds_read_b64_tr_b16 v[130:131], v160 offset:8704
    ds_read_b64_tr_b16 v[132:133], v161 offset:8192
    ds_read_b64_tr_b16 v[134:135], v161 offset:8704
    ds_read_b64_tr_b16 v[136:137], v162 offset:8192
    ds_read_b64_tr_b16 v[138:139], v162 offset:8704
    ds_read_b64_tr_b16 v[140:141], v163 offset:8192
    ds_read_b64_tr_b16 v[142:143], v163 offset:8704
    s_waitcnt lgkmcnt(7)
    ds_read_b64_tr_b16 v[144:145], v160 offset:12288
    ds_read_b64_tr_b16 v[146:147], v160 offset:12800
    ds_read_b64_tr_b16 v[148:149], v161 offset:12288
    ds_read_b64_tr_b16 v[150:151], v161 offset:12800
    ds_read_b64_tr_b16 v[152:153], v162 offset:12288
    ds_read_b64_tr_b16 v[154:155], v162 offset:12800
    ds_read_b64_tr_b16 v[156:157], v163 offset:12288
    ds_read_b64_tr_b16 v[158:159], v163 offset:12800
    s_waitcnt lgkmcnt(7)
    s_waitcnt lgkmcnt(0)
    s_cmp_gt_u32 s60, 0
    s_cbranch_scc1 L_thr0_v13
    s_waitcnt vmcnt(3)
L_thr0_v13:
    s_cmp_gt_u32 s60, 1
    s_cbranch_scc1 L_thr1_v13
    s_waitcnt vmcnt(4)
L_thr1_v13:
    s_mov_b32 s90, 106496
    buffer_load_dwordx4 v[228:231], v2, s[36:39], s90 offen offset:0 nt
    buffer_load_dwordx2 v[178:179], v4, s[52:55], 0 offen offset:1024
    buffer_load_dwordx2 v[180:181], v4, s[52:55], 0 offen offset:2048
    s_cmp_gt_u32 s60, 0
    s_cbranch_scc1 L_thr0_v14
    s_waitcnt vmcnt(5)
L_thr0_v14:
    s_cmp_gt_u32 s60, 1
    s_cbranch_scc1 L_thr1_v14
    s_waitcnt vmcnt(6)
L_thr1_v14:
    s_mov_b32 s90, 114688
    buffer_load_dwordx4 v[232:235], v2, s[36:39], s90 offen offset:0 nt
    buffer_load_dwordx2 v[182:183], v4, s[52:55], 0 offen offset:3072
    s_cmp_gt_u32 s60, 0
    s_cbranch_scc1 L_thr0_v15
    s_waitcnt vmcnt(6)
L_thr0_v15:
    s_cmp_gt_u32 s60, 1
    s_cbranch_scc1 L_thr1_v15
    s_waitcnt vmcnt(7)
L_thr1_v15:
    s_mov_b32 s90, 122880
    buffer_load_dwordx4 v[236:239], v2, s[36:39], s90 offen offset:0 nt
    s_mov_b32 s90, 4096
    buffer_load_dwordx2 v[184:185], v4, s[52:55], s90 offen offset:0
    s_mov_b32 s90, 4096
    buffer_load_dwordx2 v[186:187], v4, s[52:55], s90 offen offset:1024
    s_cmp_gt_u32 s60, 0
    s_cbranch_scc1 L_thr0_v16
    s_waitcnt vmcnt(7)
L_thr0_v16:
    s_cmp_gt_u32 s60, 1
    s_cbranch_scc1 L_thr1_v16
    s_waitcnt vmcnt(9)
L_thr1_v16:
    s_waitcnt vmcnt(13)
    s_setprio 1
    s_mov_b32 s90, 131072
    buffer_load_dwordx4 v[240:243], v2, s[36:39], s90 offen offset:0 nt
    s_mov_b32 s90, 4096
    buffer_load_dwordx2 v[188:189], v4, s[52:55], s90 offen offset:2048
    v_perm_b32 v12, v36, v36, v8
    v_perm_b32 v13, v36, v36, v9
    s_nop 1
    v_mfma_f32_16x16x16_bf16 v[16:19], v[12:13], v[208:209], v[16:19]
    v_mfma_f32_16x16x16_bf16 v[20:23], v[12:13], v[210:211], v[20:23]
    s_cmp_gt_u32 s60, 0
    s_cbranch_scc1 L_thr0_v17
    s_waitcnt vmcnt(6)
L_thr0_v17:
    s_cmp_gt_u32 s60, 1
    s_cbranch_scc1 L_thr1_v17
    s_waitcnt vmcnt(9)
L_thr1_v17:
    s_waitcnt vmcnt(14)
    s_mov_b32 s90, 139264
    buffer_load_dwordx4 v[244:247], v2, s[36:39], s90 offen offset:0 nt
    s_mov_b32 s90, 4096
    buffer_load_dwordx2 v[190:191], v4, s[52:55], s90 offen offset:3072
    s_mov_b32 s90, 32768
    buffer_load_dwordx2 v[192:193], v4, s[52:55], s90 offen offset:0
    v_perm_b32 v14, v36, v36, v10
    v_perm_b32 v15, v36, v36, v11
    s_nop 1
    v_mfma_f32_16x16x16_bf16 v[16:19], v[14:15], v[212:213], v[16:19]
    v_mfma_f32_16x16x16_bf16 v[20:23], v[14:15], v[214:215], v[20:23]
    s_barrier
    s_cmp_gt_u32 s60, 0
    s_cbranch_scc1 L_thr0_v18
    s_waitcnt vmcnt(7)
L_thr0_v18:
    s_cmp_gt_u32 s60, 1
    s_cbranch_scc1 L_thr1_v18
    s_waitcnt vmcnt(9)
L_thr1_v18:
    s_waitcnt vmcnt(16)
    s_mov_b32 s90, 147456
    buffer_load_dwordx4 v[248:251], v2, s[36:39], s90 offen offset:0 nt
    s_mov_b32 s90, 32768
    buffer_load_dwordx2 v[194:195], v4, s[52:55], s90 offen offset:1024
    v_perm_b32 v12, v37, v37, v8
    v_perm_b32 v13, v37, v37, v9
    s_nop 1
    v_mfma_f32_16x16x16_bf16 v[16:19], v[12:13], v[216:217], v[16:19]
    v_mfma_f32_16x16x16_bf16 v[20:23], v[12:13], v[218:219], v[20:23]
    s_cmp_gt_u32 s60, 0
    s_cbranch_scc1 L_thr0_v19
    s_waitcnt vmcnt(6)
L_thr0_v19:
    s_cmp_gt_u32 s60, 1
    s_cbranch_scc1 L_thr1_v19
    s_waitcnt vmcnt(9)
L_thr1_v19:
    s_waitcnt vmcnt(17)
    s_mov_b32 s90, 155648
    buffer_load_dwordx4 v[252:255], v2, s[36:39], s90 offen offset:0 nt
    s_mov_b32 s90, 32768
    buffer_load_dwordx2 v[196:197], v4, s[52:55], s90 offen offset:2048
    s_mov_b32 s90, 32768
    buffer_load_dwordx2 v[198:199], v4, s[52:55], s90 offen offset:3072
    v_perm_b32 v14, v37, v37, v10
    v_perm_b32 v15, v37, v37, v11
    s_nop 1
    v_mfma_f32_16x16x16_bf16 v[16:19], v[14:15], v[220:221], v[16:19]
    v_mfma_f32_16x16x16_bf16 v[20:23], v[14:15], v[222:223], v[20:23]
    s_cmp_gt_u32 s60, 0
    s_cbranch_scc1 L_thr0_v20
    s_waitcnt vmcnt(7)
L_thr0_v20:
    s_cmp_gt_u32 s60, 1
    s_cbranch_scc1 L_thr1_v20
    s_waitcnt vmcnt(9)
L_thr1_v20:
    s_waitcnt vmcnt(19)
    s_mov_b32 s90, 163840
    buffer_load_dwordx4 v[48:51], v2, s[36:39], s90 offen offset:0 nt
    s_mov_b32 s90, 36864
    buffer_load_dwordx2 v[200:201], v4, s[52:55], s90 offen offset:0
    v_perm_b32 v12, v38, v38, v8
    v_perm_b32 v13, v38, v38, v9
    s_nop 1
    v_mfma_f32_16x16x16_bf16 v[16:19], v[12:13], v[224:225], v[16:19]
    v_mfma_f32_16x16x16_bf16 v[20:23], v[12:13], v[226:227], v[20:23]
    s_cmp_gt_u32 s60, 0
    s_cbranch_scc1 L_thr0_v21
    s_waitcnt vmcnt(6)
L_thr0_v21:
    s_cmp_gt_u32 s60, 1
    s_cbranch_scc1 L_thr1_v21
    s_waitcnt vmcnt(9)
L_thr1_v21:
    s_waitcnt vmcnt(19)
    s_mov_b32 s90, 172032
    buffer_load_dwordx4 v[52:55], v2, s[36:39], s90 offen offset:0 nt
    s_mov_b32 s90, 36864
    buffer_load_dwordx2 v[202:203], v4, s[52:55], s90 offen offset:1024
    s_mov_b32 s90, 36864
    buffer_load_dwordx2 v[204:205], v4, s[52:55], s90 offen offset:2048
    v_perm_b32 v14, v38, v38, v10
    v_perm_b32 v15, v38, v38, v11
    s_nop 1
    v_mfma_f32_16x16x16_bf16 v[16:19], v[14:15], v[228:229], v[16:19]
    v_mfma_f32_16x16x16_bf16 v[20:23], v[14:15], v[230:231], v[20:23]
    s_barrier
    s_cmp_gt_u32 s60, 0
    s_cbranch_scc1 L_thr0_v22
    s_waitcnt vmcnt(7)
L_thr0_v22:
    s_cmp_gt_u32 s60, 1
    s_cbranch_scc1 L_thr1_v22
    s_waitcnt vmcnt(9)
L_thr1_v22:
    s_waitcnt vmcnt(19)
    s_mov_b32 s90, 180224
    buffer_load_dwordx4 v[56:59], v2, s[36:39], s90 offen offset:0 nt
    s_mov_b32 s90, 36864
    buffer_load_dwordx2 v[206:207], v4, s[52:55], s90 offen offset:3072
    v_perm_b32 v12, v39, v39, v8
    v_perm_b32 v13, v39, v39, v9
    s_nop 1
    v_mfma_f32_16x16x16_bf16 v[16:19], v[12:13], v[232:233], v[16:19]
    v_mfma_f32_16x16x16_bf16 v[20:23], v[12:13], v[234:235], v[20:23]
    s_cmp_gt_u32 s60, 0
    s_cbranch_scc1 L_thr0_v23
    s_waitcnt vmcnt(6)
L_thr0_v23:
    s_cmp_gt_u32 s60, 1
    s_cbranch_scc1 L_thr1_v23
    s_waitcnt vmcnt(9)
L_thr1_v23:
    s_waitcnt vmcnt(19)
    s_mov_b32 s90, 188416
    buffer_load_dwordx4 v[60:63], v2, s[36:39], s90 offen offset:0 nt
    v_perm_b32 v14, v39, v39, v10
    v_perm_b32 v15, v39, v39, v11
    s_nop 1
    v_mfma_f32_16x16x16_bf16 v[16:19], v[14:15], v[236:237], v[16:19]
    v_mfma_f32_16x16x16_bf16 v[20:23], v[14:15], v[238:239], v[20:23]
    s_mov_b32 s91, 400015
    v_mov_b32 v31, 0
L_cnt_16:
    ds_read_b32 v29, v31 offset:1032
    s_waitcnt lgkmcnt(0)
    v_readfirstlane_b32 s95, v29
    s_cmp_eq_u32 s95, 8
    s_cbranch_scc1 L_done_17
    s_sub_u32 s91, s91, 1
    s_cbranch_scc0 L_cnt_16
L_done_17:
    v_lshrrev_b32 v31, 4, v0
    v_lshlrev_b32 v31, 5, v31
    s_lshl_b32 s95, s84, 2
    v_add_u32 v29, s95, v31
    ds_read_b128 v[160:163], v31 offset:1152
    ds_read_b128 v[164:167], v31 offset:1168
    ds_read_b128 v[168:171], v31 offset:1280
    ds_read_b128 v[172:175], v31 offset:1296
    ds_read_b32 v30, v29 offset:1152
    s_waitcnt lgkmcnt(0)
    v_max3_f32 v5, v160, v161, v162
    v_max3_f32 v5, v5, v163, v164
    v_max3_f32 v5, v5, v165, v166
    v_max_f32 v5, v5, v167
    v_sub_f32 v160, v160, v5
    v_sub_f32 v161, v161, v5
    v_sub_f32 v162, v162, v5
    v_sub_f32 v163, v163, v5
    v_sub_f32 v164, v164, v5
    v_sub_f32 v165, v165, v5
    v_sub_f32 v166, v166, v5
    v_sub_f32 v167, v167, v5
    v_sub_f32 v30, v30, v5
    v_mul_f32 v160, s94, v160
    v_mul_f32 v161, s94, v161
    v_mul_f32 v162, s94, v162
    v_mul_f32 v163, s94, v163
    v_mul_f32 v164, s94, v164
    v_mul_f32 v165, s94, v165
    v_mul_f32 v166, s94, v166
    v_mul_f32 v167, s94, v167
    v_mul_f32 v30, s94, v30
    v_exp_f32 v160, v160
    v_exp_f32 v161, v161
    v_exp_f32 v162, v162
    v_exp_f32 v163, v163
    v_exp_f32 v164, v164
    v_exp_f32 v165, v165
    v_exp_f32 v166, v166
    v_exp_f32 v167, v167
    v_exp_f32 v30, v30
    v_mul_f32 v6, v160, v168
    v_fmac_f32 v6, v161, v169
    v_fmac_f32 v6, v162, v170
    v_fmac_f32 v6, v163, v171
    v_fmac_f32 v6, v164, v172
    v_fmac_f32 v6, v165, v173
    v_fmac_f32 v6, v166, v174
    v_fmac_f32 v6, v167, v175
    v_or_b32 v160, s85, v5
    v_and_or_b32 v161, v6, v7, s86
    v_mov_b32 v162, s87
    v_mov_b32 v163, s88
    s_lshr_b32 s95, s84, 1
    s_lshl_b32 s95, s95, 4
    v_readlane_b32 s74, v160, s95
    v_readlane_b32 s75, v161, s95
    s_lshl_b32 s95, s81, 5
    s_add_u32 s95, s95, s98
    s_lshl_b32 s95, s95, 7
    s_add_u32 s95, s95, 32768
    s_xor_b32 s96, s84, 1
    v_bfe_u32 v29, v0, 1, 3
    v_add_u32 v29, s96, v29
    v_lshlrev_b32 v29, 22, v29
    v_lshrrev_b32 v31, 1, v31
    v_add3_u32 v29, v29, v31, s95
    v_and_b32 v31, 1, v0
    v_lshl_add_u32 v168, v31, 6, v29
    v_mov_b32 v172, v160
    v_mov_b32 v173, v161
    v_mov_b32 v174, v162
    v_mov_b32 v175, v163
    buffer_store_dwordx4 v[172:175], v168, s[40:43], 0 offen
    s_cmp_gt_u32 s60, 0
    s_cbranch_scc1 L_thr0_v24
    s_waitcnt vmcnt(6)
L_thr0_v24:
    s_cmp_gt_u32 s60, 1
    s_cbranch_scc1 L_thr1_v24
    s_waitcnt vmcnt(8)
L_thr1_v24:
    s_waitcnt vmcnt(18)
    s_setprio 0
    s_mov_b32 s90, 196608
    buffer_load_dwordx4 v[64:67], v2, s[36:39], s90 offen offset:0 nt
    v_perm_b32 v12, v40, v40, v8
    v_perm_b32 v13, v40, v40, v9
    s_nop 1
    v_mfma_f32_16x16x16_bf16 v[16:19], v[12:13], v[240:241], v[16:19]
    v_mfma_f32_16x16x16_bf16 v[20:23], v[12:13], v[242:243], v[20:23]
    v_lshlrev_b32 v160, 4, v0
    v_add_u32 v160, s100, v160
    s_and_b32 s96, s81, 6
    s_lshl_b32 s96, s96, 3
    s_add_u32 s96, s96, s80
    s_lshl_b32 s96, s96, 13
    s_lshl_b32 s97, s84, 8
    s_add_u32 s96, s96, s97
    s_add_u32 s96, s96, 524288
    v_lshrrev_b32 v3, 4, v0
    v_lshlrev_b32 v3, 11, v3
    v_and_b32 v31, 15, v0
    v_lshl_add_u32 v3, v31, 4, v3
    v_add_u32 v3, s96, v3
    s_lshl_b32 s96, s84, 6
    v_add_u32 v163, s96, v0
    v_and_b32 v161, 1, v163
    v_mul_u32_u24 v161, 1152, v161
    v_lshrrev_b32 v31, 1, v163
    v_lshl_add_u32 v161, v31, 4, v161
    v_add_u32 v161, 32768, v161
    v_add_u32 v162, 0x10000, v161
    s_lshl_b32 s95, s81, 5
    s_add_u32 s95, s95, s98
    s_lshl_b32 s95, s95, 11
    s_add_u32 s95, s95, 524288
    v_lshlrev_b32 v163, 4, v163
    v_add_u32 v163, s95, v163
    s_lshl_b32 s95, s84, 8
    s_add_u32 s95, s95, 1536
    v_lshrrev_b32 v31, 4, v0
    v_and_b32 v5, 15, v0
    v_lshlrev_b32 v5, 3, v5
    v_lshl_add_u32 v5, v31, 1, v5
    v_add_u32 v5, s95, v5
    v_and_b32 v6, 1, v0
    v_lshlrev_b32 v6, 7, v6
    v_lshl_add_u32 v6, v31, 4, v6
    v_add_u32 v6, s95, v6
    s_cmp_gt_u32 s60, 0
    s_cbranch_scc1 L_thr0_v25
    s_waitcnt vmcnt(4)
L_thr0_v25:
    s_cmp_gt_u32 s60, 1
    s_cbranch_scc1 L_thr1_v25
    s_waitcnt vmcnt(7)
L_thr1_v25:
    s_waitcnt vmcnt(17)
    s_mov_b32 s90, 204800
    buffer_load_dwordx4 v[68:71], v2, s[36:39], s90 offen offset:0 nt
    v_perm_b32 v14, v40, v40, v10
    v_perm_b32 v15, v40, v40, v11
    s_nop 1
    v_mfma_f32_16x16x16_bf16 v[16:19], v[14:15], v[244:245], v[16:19]
    v_mfma_f32_16x16x16_bf16 v[20:23], v[14:15], v[246:247], v[20:23]
    s_barrier
    s_cmp_gt_u32 s60, 0
    s_cbranch_scc1 L_thr0_v26
    s_waitcnt vmcnt(3)
L_thr0_v26:
    s_cmp_gt_u32 s60, 1
    s_cbranch_scc1 L_thr1_v26
    s_waitcnt vmcnt(5)
L_thr1_v26:
    s_waitcnt vmcnt(15)
    s_mov_b32 s90, 212992
    buffer_load_dwordx4 v[72:75], v2, s[36:39], s90 offen offset:0 nt
    v_perm_b32 v12, v41, v41, v8
    v_perm_b32 v13, v41, v41, v9
    s_nop 1
    v_mfma_f32_16x16x16_bf16 v[16:19], v[12:13], v[248:249], v[16:19]
    v_mfma_f32_16x16x16_bf16 v[20:23], v[12:13], v[250:251], v[20:23]
    s_cmp_gt_u32 s60, 0
    s_cbranch_scc1 L_thr0_v27
    s_waitcnt vmcnt(2)
L_thr0_v27:
    s_cmp_gt_u32 s60, 1
    s_cbranch_scc1 L_thr1_v27
    s_waitcnt vmcnt(4)
L_thr1_v27:
    s_waitcnt vmcnt(14)
    s_mov_b32 s90, 221184
    buffer_load_dwordx4 v[76:79], v2, s[36:39], s90 offen offset:0 nt
    v_perm_b32 v14, v41, v41, v10
    v_perm_b32 v15, v41, v41, v11
    s_nop 1
    v_mfma_f32_16x16x16_bf16 v[16:19], v[14:15], v[252:253], v[16:19]
    v_mfma_f32_16x16x16_bf16 v[20:23], v[14:15], v[254:255], v[20:23]
    v_perm_b32 v31, v27, v26, s93
    ds_write_b16 v5, v31
    ds_write_b16_d16_hi v5, v31 offset:128
    ds_read_b128 v[248:251], v6
    ds_read_b128 v[252:255], v6 offset:64
    s_lshl_b32 s95, s84, 9
    s_add_u32 s95, s95, 24576
    v_and_b32 v31, 15, v0
    v_lshlrev_b32 v31, 2, v31
    v_add_u32 v31, s95, v31
    s_waitcnt lgkmcnt(0)
    v_mfma_f32_16x16x32_bf16 v[240:243], v[248:251], v[128:131], 0
    v_mfma_f32_16x16x32_bf16 v[244:247], v[248:251], v[132:135], 0
    v_mfma_f32_16x16x32_bf16 v[240:243], v[252:255], v[144:147], v[240:243]
    v_mfma_f32_16x16x32_bf16 v[244:247], v[252:255], v[148:151], v[244:247]
    s_mov_b64 exec, 0xffff
    s_nop 5
    ds_write2_b32 v31, v240, v241 offset0:0 offset1:64
    ds_write2_b32 v31, v244, v245 offset0:16 offset1:80
    s_mov_b64 exec, -1
    s_waitcnt lgkmcnt(0)
    v_mfma_f32_16x16x32_bf16 v[240:243], v[248:251], v[136:139], 0
    v_mfma_f32_16x16x32_bf16 v[244:247], v[248:251], v[140:143], 0
    v_mfma_f32_16x16x32_bf16 v[240:243], v[252:255], v[152:155], v[240:243]
    v_mfma_f32_16x16x32_bf16 v[244:247], v[252:255], v[156:159], v[244:247]
    s_mov_b64 exec, 0xffff
    s_nop 5
    ds_write2_b32 v31, v240, v241 offset0:32 offset1:96
    ds_write2_b32 v31, v244, v245 offset0:48 offset1:112
    s_mov_b64 exec, -1
    s_waitcnt lgkmcnt(0)
    s_cmp_gt_u32 s60, 0
    s_cbranch_scc1 L_thr0_v28
    s_waitcnt vmcnt(2)
L_thr0_v28:
    s_cmp_gt_u32 s60, 1
    s_cbranch_scc1 L_thr1_v28
    s_waitcnt vmcnt(3)
L_thr1_v28:
    s_waitcnt vmcnt(12)
    s_mov_b32 s90, 229376
    buffer_load_dwordx4 v[80:83], v2, s[36:39], s90 offen offset:0 nt
    v_perm_b32 v12, v42, v42, v8
    v_perm_b32 v13, v42, v42, v9
    s_nop 1
    v_mfma_f32_16x16x16_bf16 v[16:19], v[12:13], v[48:49], v[16:19]
    v_mfma_f32_16x16x16_bf16 v[20:23], v[12:13], v[50:51], v[20:23]
    s_cmp_gt_u32 s60, 0
    s_cbranch_scc1 L_thr0_v29
    s_waitcnt vmcnt(2)
L_thr0_v29:
    s_cmp_gt_u32 s60, 1
    s_cbranch_scc1 L_thr1_v29
    s_waitcnt vmcnt(3)
L_thr1_v29:
    s_waitcnt vmcnt(11)
    s_mov_b32 s90, 237568
    buffer_load_dwordx4 v[84:87], v2, s[36:39], s90 offen offset:0 nt
    v_perm_b32 v14, v42, v42, v10
    v_perm_b32 v15, v42, v42, v11
    s_nop 1
    v_mfma_f32_16x16x16_bf16 v[16:19], v[14:15], v[52:53], v[16:19]
    v_mfma_f32_16x16x16_bf16 v[20:23], v[14:15], v[54:55], v[20:23]
    s_and_b32 s95, s81, 6
    s_lshl_b32 s95, s95, 3
    s_add_u32 s95, s95, s80
    s_lshl_b32 s95, s95, 9
    s_lshr_b32 s96, s84, 1
    s_lshl_b32 s96, s96, 4
    s_add_u32 s95, s95, s96
    s_add_u32 s95, s95, 32768
    v_lshrrev_b32 v1, 4, v0
    v_lshlrev_b32 v1, 7, v1
    v_add_u32 v1, s95, v1
    buffer_load_dwordx4 v[32:35], v1, s[40:43], 0 offen offset:0 sc1
    s_mov_b32 s90, 4096
    buffer_load_dwordx4 v[36:39], v1, s[40:43], s90 offen offset:0 sc1
    s_barrier
    s_cmp_gt_u32 s60, 0
    s_cbranch_scc1 L_thr0_v30
    s_waitcnt vmcnt(4)
L_thr0_v30:
    s_cmp_gt_u32 s60, 1
    s_cbranch_scc1 L_thr1_v30
    s_waitcnt vmcnt(5)
L_thr1_v30:
    s_waitcnt vmcnt(11)
    s_mov_b32 s90, 245760
    buffer_load_dwordx4 v[88:91], v2, s[36:39], s90 offen offset:0 nt
    v_perm_b32 v12, v43, v43, v8
    v_perm_b32 v13, v43, v43, v9
    s_nop 1
    v_mfma_f32_16x16x16_bf16 v[16:19], v[12:13], v[56:57], v[16:19]
    v_mfma_f32_16x16x16_bf16 v[20:23], v[12:13], v[58:59], v[20:23]
    s_cmp_gt_u32 s60, 0
    s_cbranch_scc1 L_thr0_v31
    s_waitcnt vmcnt(4)
L_thr0_v31:
    s_cmp_gt_u32 s60, 1
    s_cbranch_scc1 L_thr1_v31
    s_waitcnt vmcnt(5)
L_thr1_v31:
    s_waitcnt vmcnt(10)
    s_mov_b32 s90, 253952
    buffer_load_dwordx4 v[92:95], v2, s[36:39], s90 offen offset:0 nt
    v_perm_b32 v14, v43, v43, v10
    v_perm_b32 v15, v43, v43, v11
    s_nop 1
    v_mfma_f32_16x16x16_bf16 v[16:19], v[14:15], v[60:61], v[16:19]
    v_mfma_f32_16x16x16_bf16 v[20:23], v[14:15], v[62:63], v[20:23]
    v_perm_b32 v208, v178, v176, s92
    v_perm_b32 v209, v182, v180, s92
    v_perm_b32 v210, v186, v184, s92
    v_perm_b32 v211, v190, v188, s92
    v_perm_b32 v212, v178, v176, s93
    v_perm_b32 v213, v182, v180, s93
    v_perm_b32 v214, v186, v184, s93
    v_perm_b32 v215, v190, v188, s93
    v_perm_b32 v216, v179, v177, s92
    v_perm_b32 v217, v183, v181, s92
    v_perm_b32 v218, v187, v185, s92
    v_perm_b32 v219, v191, v189, s92
    v_perm_b32 v220, v179, v177, s93
    v_perm_b32 v221, v183, v181, s93
    v_perm_b32 v222, v187, v185, s93
    v_perm_b32 v223, v191, v189, s93
    v_perm_b32 v224, v194, v192, s92
    v_perm_b32 v225, v198, v196, s92
    v_perm_b32 v226, v202, v200, s92
    v_perm_b32 v227, v206, v204, s92
    v_perm_b32 v228, v194, v192, s93
    v_perm_b32 v229, v198, v196, s93
    v_perm_b32 v230, v202, v200, s93
    v_perm_b32 v231, v206, v204, s93
    v_perm_b32 v232, v195, v193, s92
    v_perm_b32 v233, v199, v197, s92
    v_perm_b32 v234, v203, v201, s92
    v_perm_b32 v235, v207, v205, s92
    v_perm_b32 v236, v195, v193, s93
    v_perm_b32 v237, v199, v197, s93
    v_perm_b32 v238, v203, v201, s93
    v_perm_b32 v239, v207, v205, s93
    v_perm_b32 v12, v44, v44, v8
    v_perm_b32 v13, v44, v44, v9
    s_waitcnt vmcnt(9)
    s_nop 0
    v_mfma_f32_16x16x16_bf16 v[16:19], v[12:13], v[64:65], v[16:19]
    v_mfma_f32_16x16x16_bf16 v[20:23], v[12:13], v[66:67], v[20:23]
    v_perm_b32 v14, v44, v44, v10
    v_perm_b32 v15, v44, v44, v11
    s_waitcnt vmcnt(8)
    s_nop 0
    v_mfma_f32_16x16x16_bf16 v[16:19], v[14:15], v[68:69], v[16:19]
    v_mfma_f32_16x16x16_bf16 v[20:23], v[14:15], v[70:71], v[20:23]
    v_perm_b32 v12, v45, v45, v8
    v_perm_b32 v13, v45, v45, v9
    s_waitcnt vmcnt(7)
    s_nop 0
    v_mfma_f32_16x16x16_bf16 v[16:19], v[12:13], v[72:73], v[16:19]
    v_mfma_f32_16x16x16_bf16 v[20:23], v[12:13], v[74:75], v[20:23]
    v_perm_b32 v14, v45, v45, v10
    v_perm_b32 v15, v45, v45, v11
    s_waitcnt vmcnt(6)
    s_nop 0
    v_mfma_f32_16x16x16_bf16 v[16:19], v[14:15], v[76:77], v[16:19]
    v_mfma_f32_16x16x16_bf16 v[20:23], v[14:15], v[78:79], v[20:23]
    v_perm_b32 v12, v46, v46, v8
    v_perm_b32 v13, v46, v46, v9
    s_waitcnt vmcnt(5)
    s_nop 0
    v_mfma_f32_16x16x16_bf16 v[16:19], v[12:13], v[80:81], v[16:19]
    v_mfma_f32_16x16x16_bf16 v[20:23], v[12:13], v[82:83], v[20:23]
    s_waitcnt vmcnt(2)
    s_lshl_b32 s95, s82, 4
    s_mov_b64 s[72:73], 0xffff
    s_lshl_b64 s[72:73], s[72:73], s95
    s_mov_b32 s91, 400015
    s_mov_b64 exec, s[72:73]
    s_bitcmp1_b32 s81, 0
    s_cbranch_scc1 L_own_20a
    v_mov_b32 v32, s74
    v_mov_b32 v33, s75
    v_mov_b32 v34, s87
    v_mov_b32 v35, s88
    s_branch L_own_20b
L_own_20a:
    v_mov_b32 v36, s74
    v_mov_b32 v37, s75
    v_mov_b32 v38, s87
    v_mov_b32 v39, s88
L_own_20b:
    s_mov_b64 exec, -1
    v_xor_b32 v32, s85, v32
    v_xor_b32 v33, s86, v33
    v_xor_b32 v34, s87, v34
    v_xor_b32 v35, s88, v35
    v_or3_b32 v31, v32, v33, v34
    v_or_b32 v31, v31, v35
    v_xor_b32 v36, s85, v36
    v_xor_b32 v37, s86, v37
    v_xor_b32 v38, s87, v38
    v_xor_b32 v39, s88, v39
    v_or3_b32 v31, v31, v36, v37
    v_or3_b32 v31, v31, v38, v39
    v_and_b32 v31, 0xff, v31
    v_cmp_ne_u32 vcc, 0, v31
    s_cbranch_vccz L_ok_19
L_poll_18:
    s_sleep 8
    s_and_b32 s95, s91, 7
    s_cbranch_scc1 L_st_soon
    s_xor_b32 s95, s84, 1
    s_lshl_b32 s95, s95, 22
    v_subrev_u32 v169, s95, v168
    s_mov_b32 s90, 1605632
    buffer_store_dwordx4 v[172:175], v169, s[40:43], s90 offen sc1
    s_cmp_lg_u32 s83, 2
    s_cbranch_scc1 L_noq2_21
    v_lshlrev_b32 v170, 4, v0
    v_lshrrev_b32 v171, 5, v0
    v_mul_u32_u24 v171, 15872, v171
    v_add_u32 v171, v171, v170
    s_lshl_b32 s95, s3, 9
    s_add_u32 s95, s95, 1703936
    ds_read_b128 v[164:167], v170 offset:20480
    s_waitcnt lgkmcnt(0)
    buffer_store_dwordx4 v[164:167], v171, s[40:43], s95 offen sc1
    s_add_u32 s95, s95, 32768
    s_nop 0
    ds_read_b128 v[164:167], v170 offset:21504
    s_waitcnt lgkmcnt(0)
    buffer_store_dwordx4 v[164:167], v171, s[40:43], s95 offen sc1
    s_add_u32 s95, s95, 32768
    s_nop 0
    ds_read_b128 v[164:167], v170 offset:22528
    s_waitcnt lgkmcnt(0)
    buffer_store_dwordx4 v[164:167], v171, s[40:43], s95 offen sc1
    s_add_u32 s95, s95, 32768
    s_nop 0
    ds_read_b128 v[164:167], v170 offset:23552
    s_waitcnt lgkmcnt(0)
    buffer_store_dwordx4 v[164:167], v171, s[40:43], s95 offen sc1
    s_add_u32 s95, s95, 32768
    s_nop 0
L_noq2_21:
L_st_soon:
    s_and_b32 s95, s91, 7
    s_cselect_b32 s95, 0, 1605632
    s_add_u32 s96, s95, 4096
    buffer_load_dwordx4 v[32:35], v1, s[40:43], s95 offen sc1
    buffer_load_dwordx4 v[36:39], v1, s[40:43], s96 offen sc1
    s_waitcnt vmcnt(0)
    s_mov_b64 exec, s[72:73]
    s_bitcmp1_b32 s81, 0
    s_cbranch_scc1 L_own_22a
    v_mov_b32 v32, s74
    v_mov_b32 v33, s75
    v_mov_b32 v34, s87
    v_mov_b32 v35, s88
    s_branch L_own_22b
L_own_22a:
    v_mov_b32 v36, s74
    v_mov_b32 v37, s75
    v_mov_b32 v38, s87
    v_mov_b32 v39, s88
L_own_22b:
    s_mov_b64 exec, -1
    v_xor_b32 v32, s85, v32
    v_xor_b32 v33, s86, v33
    v_xor_b32 v34, s87, v34
    v_xor_b32 v35, s88, v35
    v_or3_b32 v31, v32, v33, v34
    v_or_b32 v31, v31, v35
    v_xor_b32 v36, s85, v36
    v_xor_b32 v37, s86, v37
    v_xor_b32 v38, s87, v38
    v_xor_b32 v39, s88, v39
    v_or3_b32 v31, v31, v36, v37
    v_or3_b32 v31, v31, v38, v39
    v_and_b32 v31, 0xff, v31
    v_cmp_ne_u32 vcc, 0, v31
    s_cbranch_vccz L_done_23
    s_sub_u32 s91, s91, 1
    s_cbranch_scc0 L_poll_18
L_done_23:
L_ok_19:
    s_nop 1
    v_mov_b32 v34, v32
    v_mov_b32 v38, v36
    v_mov_b32 v35, v34
    s_nop 1
    v_permlane16_swap_b32 v35, v34
    v_max_f32 v34, v34, v35
    v_mov_b32 v35, v34
    s_nop 1
    v_permlane32_swap_b32 v35, v34
    v_max_f32 v34, v34, v35
    v_mov_b32 v39, v38
    s_nop 1
    v_permlane16_swap_b32 v39, v38
    v_max_f32 v38, v38, v39
    v_mov_b32 v39, v38
    s_nop 1
    v_permlane32_swap_b32 v39, v38
    v_max_f32 v38, v38, v39
    v_sub_f32 v32, v32, v34
    v_sub_f32 v36, v36, v38
    v_mul_f32 v32, s94, v32
    v_mul_f32 v36, s94, v36
    v_exp_f32 v32, v32
    v_exp_f32 v36, v36
    v_mul_f32 v33, v33, v32
    v_mul_f32 v37, v37, v36
    v_mov_b32 v35, v33
    s_nop 1
    v_permlane16_swap_b32 v35, v33
    v_add_f32 v33, v33, v35
    v_mov_b32 v35, v33
    s_nop 1
    v_permlane32_swap_b32 v35, v33
    v_add_f32 v33, v33, v35
    v_mov_b32 v39, v37
    s_nop 1
    v_permlane16_swap_b32 v39, v37
    v_add_f32 v37, v37, v39
    v_mov_b32 v39, v37
    s_nop 1
    v_permlane32_swap_b32 v39, v37
    v_add_f32 v37, v37, v39
    v_rcp_f32 v33, v33
    v_rcp_f32 v37, v37
    v_mul_f32 v29, v32, v33
    v_mul_f32 v40, v36, v37
    v_lshrrev_b32 v31, 4, v0
    s_lshl_b32 s95, s84, 9
    s_add_u32 s95, s95, 7680
    v_and_b32 v2, 15, v0
    v_lshlrev_b32 v2, 2, v2
    v_add_u32 v2, s95, v2
    s_and_b32 s95, s81, 6
    s_lshl_b32 s95, s95, 14
    s_lshl_b32 s96, s98, 9
    s_add_u32 s95, s95, s96
    s_and_b32 s96, s81, 1
    s_lshl_b32 s96, s96, 8
    s_add_u32 s95, s95, s96
    s_add_u32 s95, s95, 262144
    v_and_b32 v4, 15, v0
    v_lshlrev_b32 v4, 4, v4
    v_lshl_add_u32 v1, v31, 11, v4
    v_lshl_add_u32 v4, v31, 14, v4
    v_add_u32 v4, s95, v4
    s_lshl_b32 s95, s81, 14
    s_lshl_b32 s96, s84, 8
    s_add_u32 s95, s95, s96
    s_add_u32 s95, s95, 262144
    v_add_u32 v1, s95, v1
    v_perm_b32 v14, v46, v46, v10
    v_perm_b32 v15, v46, v46, v11
    s_nop 1
    v_mfma_f32_16x16x16_bf16 v[16:19], v[14:15], v[84:85], v[16:19]
    v_mfma_f32_16x16x16_bf16 v[20:23], v[14:15], v[86:87], v[20:23]
    v_perm_b32 v12, v47, v47, v8
    v_perm_b32 v13, v47, v47, v9
    s_waitcnt vmcnt(1)
    s_nop 0
    v_mfma_f32_16x16x16_bf16 v[16:19], v[12:13], v[88:89], v[16:19]
    v_mfma_f32_16x16x16_bf16 v[20:23], v[12:13], v[90:91], v[20:23]
    v_perm_b32 v14, v47, v47, v10
    v_perm_b32 v15, v47, v47, v11
    s_waitcnt vmcnt(0)
    s_nop 0
    v_mfma_f32_16x16x16_bf16 v[16:19], v[14:15], v[92:93], v[16:19]
    v_mfma_f32_16x16x16_bf16 v[20:23], v[14:15], v[94:95], v[20:23]
    s_nop 6
    v_mul_f32 v16, v16, v30
    v_mul_f32 v17, v17, v30
    v_mul_f32 v18, v18, v30
    v_mul_f32 v19, v19, v30
    v_mul_f32 v20, v20, v30
    v_mul_f32 v21, v21, v30
    v_mul_f32 v22, v22, v30
    v_mul_f32 v23, v23, v30
    ds_write_b128 v160, v[16:19]
    ds_write_b128 v160, v[20:23] offset:1152
    s_waitcnt lgkmcnt(0)
    s_barrier
    s_cmp_ge_u32 s84, 2
    s_cbranch_scc1 L_h1
    ds_read_b128 v[48:51], v161 offset:0
    ds_read_b128 v[52:55], v161 offset:16384
    ds_read_b128 v[56:59], v161 offset:32768
    ds_read_b128 v[60:63], v161 offset:49152
    ds_read_b128 v[64:67], v162 offset:0
    ds_read_b128 v[68:71], v162 offset:16384
    ds_read_b128 v[72:75], v162 offset:32768
    ds_read_b128 v[76:79], v162 offset:49152
    s_waitcnt lgkmcnt(6)
    v_pk_add_f32 v[48:49], v[48:49], v[52:53]
    v_pk_add_f32 v[50:51], v[50:51], v[54:55]
    s_waitcnt lgkmcnt(4)
    v_pk_add_f32 v[56:57], v[56:57], v[60:61]
    v_pk_add_f32 v[58:59], v[58:59], v[62:63]
    v_pk_add_f32 v[48:49], v[48:49], v[56:57]
    v_pk_add_f32 v[50:51], v[50:51], v[58:59]
    s_waitcnt lgkmcnt(2)
    v_pk_add_f32 v[64:65], v[64:65], v[68:69]
    v_pk_add_f32 v[66:67], v[66:67], v[70:71]
    s_waitcnt lgkmcnt(0)
    v_pk_add_f32 v[72:73], v[72:73], v[76:77]
    v_pk_add_f32 v[74:75], v[74:75], v[78:79]
    v_pk_add_f32 v[64:65], v[64:65], v[72:73]
    v_pk_add_f32 v[66:67], v[66:67], v[74:75]
    v_pk_add_f32 v[48:49], v[48:49], v[64:65]
    v_pk_add_f32 v[50:51], v[50:51], v[66:67]
    v_and_or_b32 v44, v48, v7, s85
    v_and_or_b32 v45, v49, v7, s86
    v_and_or_b32 v46, v50, v7, s87
    v_and_or_b32 v47, v51, v7, s88
    buffer_store_dwordx4 v[44:47], v163, s[40:43], 0 offen
    ds_write_b128 v160, v[44:47] offset:4096
    s_waitcnt lgkmcnt(0)
L_h1:
    s_barrier
    s_mov_b32 s72, 0
    s_mov_b32 s73, 65536
    s_mov_b32 s91, 400015
    buffer_load_dwordx4 v[240:243], v3, s[40:43], s72 offen sc1
    buffer_load_dwordx4 v[244:247], v3, s[40:43], s73 offen sc1
L_pp_24:
    s_waitcnt vmcnt(0)
    v_xor_b32 v240, s85, v240
    v_xor_b32 v241, s86, v241
    v_xor_b32 v242, s87, v242
    v_xor_b32 v243, s88, v243
    v_or3_b32 v31, v240, v241, v242
    v_or_b32 v31, v31, v243
    v_xor_b32 v244, s85, v244
    v_xor_b32 v245, s86, v245
    v_xor_b32 v246, s87, v246
    v_xor_b32 v247, s88, v247
    v_or3_b32 v31, v31, v244, v245
    v_or3_b32 v31, v31, v246, v247
    v_and_b32 v31, 0xff, v31
    v_cmp_ne_u32 vcc, 0, v31
    s_cbranch_vccz L_ppok_26
    s_and_b32 s95, s91, 15
    s_cselect_b32 s72, 0, 1572864
    s_cbranch_scc1 L_o_same
    v_lshlrev_b32 v56, 4, v0
    ds_read_b128 v[48:51], v56 offset:36864
    ds_read_b128 v[52:55], v56 offset:53248
    s_lshl_b32 s95, s81, 5
    s_add_u32 s95, s95, s98
    s_lshl_b32 s95, s95, 11
    s_add_u32 s95, s95, 2097152
    s_waitcnt lgkmcnt(0)
    buffer_store_dwordx4 v[48:51], v56, s[40:43], s95 offen sc1
    buffer_store_dwordx4 v[52:55], v56, s[40:43], s95 offen offset:1024 sc1
    s_xor_b32 s95, s84, 1
    s_lshl_b32 s95, s95, 22
    v_subrev_u32 v169, s95, v168
    s_mov_b32 s90, 1605632
    buffer_store_dwordx4 v[172:175], v169, s[40:43], s90 offen sc1
    s_cmp_lg_u32 s83, 2
    s_cbranch_scc1 L_noq2_27
    v_lshlrev_b32 v170, 4, v0
    v_lshrrev_b32 v171, 5, v0
    v_mul_u32_u24 v171, 15872, v171
    v_add_u32 v171, v171, v170
    s_lshl_b32 s95, s3, 9
    s_add_u32 s95, s95, 1703936
    ds_read_b128 v[164:167], v170 offset:20480
    s_waitcnt lgkmcnt(0)
    buffer_store_dwordx4 v[164:167], v171, s[40:43], s95 offen sc1
    s_add_u32 s95, s95, 32768
    s_nop 0
    ds_read_b128 v[164:167], v170 offset:21504
    s_waitcnt lgkmcnt(0)
    buffer_store_dwordx4 v[164:167], v171, s[40:43], s95 offen sc1
    s_add_u32 s95, s95, 32768
    s_nop 0
    ds_read_b128 v[164:167], v170 offset:22528
    s_waitcnt lgkmcnt(0)
    buffer_store_dwordx4 v[164:167], v171, s[40:43], s95 offen sc1
    s_add_u32 s95, s95, 32768
    s_nop 0
    ds_read_b128 v[164:167], v170 offset:23552
    s_waitcnt lgkmcnt(0)
    buffer_store_dwordx4 v[164:167], v171, s[40:43], s95 offen sc1
    s_add_u32 s95, s95, 32768
    s_nop 0
L_noq2_27:
L_o_same:
    s_add_u32 s73, s72, 65536
    buffer_load_dwordx4 v[240:243], v3, s[40:43], s72 offen sc1
    buffer_load_dwordx4 v[244:247], v3, s[40:43], s73 offen sc1
    s_sub_u32 s91, s91, 1
    s_cbranch_scc0 L_pp_24
    s_waitcnt vmcnt(0)
L_ppok_26:
    v_mul_f32 v16, v240, v29
    v_mul_f32 v17, v241, v29
    v_mul_f32 v18, v242, v29
    v_mul_f32 v19, v243, v29
    v_mul_f32 v20, v244, v40
    v_mul_f32 v21, v245, v40
    v_mul_f32 v22, v246, v40
    v_mul_f32 v23, v247, v40
L_ppdone_25:
    v_permlane32_swap_b32 v16, v18
    v_permlane32_swap_b32 v17, v19
    v_permlane32_swap_b32 v20, v22
    v_permlane32_swap_b32 v21, v23
    v_add_f32 v16, v16, v18
    v_add_f32 v17, v17, v19
    v_add_f32 v20, v20, v22
    v_add_f32 v21, v21, v23
    v_permlane16_swap_b32 v16, v17
    s_nop 0
    v_permlane16_swap_b32 v20, v21
    v_add_f32 v16, v16, v17
    v_add_f32 v20, v20, v21
    v_cvt_pk_bf16_f32 v16, v16, v20
    ds_write_b16 v5, v16
    ds_write_b16_d16_hi v5, v16 offset:128
    ds_read_b128 v[248:251], v6
    ds_read_b128 v[252:255], v6 offset:64
    s_waitcnt lgkmcnt(1)
    v_mfma_f32_16x16x32_bf16 v[80:83], v[248:251], v[96:99], 0
    v_mfma_f32_16x16x32_bf16 v[84:87], v[248:251], v[100:103], 0
    v_mfma_f32_16x16x32_bf16 v[88:91], v[248:251], v[104:107], 0
    v_mfma_f32_16x16x32_bf16 v[92:95], v[248:251], v[108:111], 0
    s_waitcnt lgkmcnt(0)
    v_mfma_f32_16x16x32_bf16 v[80:83], v[252:255], v[112:115], v[80:83]
    v_mfma_f32_16x16x32_bf16 v[84:87], v[252:255], v[116:119], v[84:87]
    v_mfma_f32_16x16x32_bf16 v[88:91], v[252:255], v[120:123], v[88:91]
    v_mfma_f32_16x16x32_bf16 v[92:95], v[252:255], v[124:127], v[92:95]
    s_mov_b64 exec, 0xffff
    s_nop 3
    ds_write2_b32 v2, v80, v81 offset0:0 offset1:64
    ds_write2_b32 v2, v84, v85 offset0:16 offset1:80
    ds_write2_b32 v2, v88, v89 offset0:32 offset1:96
    ds_write2_b32 v2, v92, v93 offset0:48 offset1:112
    s_mov_b64 exec, -1
    v_lshlrev_b32 v2, 4, v0
    s_waitcnt lgkmcnt(0)
    s_barrier
    s_cmp_lg_u32 s84, 0
    s_cbranch_scc1 L_h2
    s_mov_b32 exec_hi, 0
    ds_read_b128 v[48:51], v2 offset:7680
    ds_read_b128 v[52:55], v2 offset:8192
    ds_read_b128 v[56:59], v2 offset:8704
    ds_read_b128 v[60:63], v2 offset:9216
    ds_read_b128 v[64:67], v2 offset:9728
    ds_read_b128 v[68:71], v2 offset:10240
    ds_read_b128 v[72:75], v2 offset:10752
    ds_read_b128 v[76:79], v2 offset:11264
    s_waitcnt lgkmcnt(6)
    v_pk_add_f32 v[48:49], v[48:49], v[52:53]
    v_pk_add_f32 v[50:51], v[50:51], v[54:55]
    s_waitcnt lgkmcnt(4)
    v_pk_add_f32 v[56:57], v[56:57], v[60:61]
    v_pk_add_f32 v[58:59], v[58:59], v[62:63]
    v_pk_add_f32 v[48:49], v[48:49], v[56:57]
    v_pk_add_f32 v[50:51], v[50:51], v[58:59]
    s_waitcnt lgkmcnt(2)
    v_pk_add_f32 v[64:65], v[64:65], v[68:69]
    v_pk_add_f32 v[66:67], v[66:67], v[70:71]
    s_waitcnt lgkmcnt(0)
    v_pk_add_f32 v[72:73], v[72:73], v[76:77]
    v_pk_add_f32 v[74:75], v[74:75], v[78:79]
    v_pk_add_f32 v[64:65], v[64:65], v[72:73]
    v_pk_add_f32 v[66:67], v[66:67], v[74:75]
    v_pk_add_f32 v[48:49], v[48:49], v[64:65]
    v_pk_add_f32 v[50:51], v[50:51], v[66:67]
    v_and_or_b32 v48, v48, v7, s85
    v_and_or_b32 v49, v49, v7, s86
    v_and_or_b32 v50, v50, v7, s87
    v_and_or_b32 v51, v51, v7, s88
    buffer_store_dwordx4 v[48:51], v4, s[40:43], 0 offen sc1
    s_mov_b64 exec, -1
L_h2:
    s_barrier
    s_lshl_b32 s95, s84, 9
    s_add_u32 s95, s95, 28672
    v_and_b32 v66, 15, v0
    v_lshlrev_b32 v2, 2, v66
    v_add_u32 v2, s95, v2
    v_lshlrev_b32 v66, 4, v66
    s_mul_i32 s96, s81, 28
    s_add_u32 s96, s96, s101
    s_lshl_b32 s96, s96, 11
    s_lshl_b32 s95, s84, 8
    s_add_u32 s96, s96, s95
    s_add_u32 s96, s96, 1048576
    v_add_u32 v67, s96, v66
    v_lshrrev_b32 v31, 4, v0
    v_lshl_add_u32 v3, v31, 2, v66
    v_add_u32 v3, s95, v3
    v_lshl_add_u32 v66, v31, 10, v66
    ds_read_b128 v[80:83], v66 offset:24576
    ds_read_b128 v[84:87], v66 offset:24832
    ds_read_b128 v[88:91], v66 offset:25088
    ds_read_b128 v[92:95], v66 offset:25344
    s_lshl_b32 s95, s84, 2
    v_and_b32 v68, 32, v0
    v_add_u32 v68, s95, v68
    v_mov_b32 v69, 0
    s_waitcnt lgkmcnt(0)
    v_pk_add_f32 v[80:81], v[80:81], v[88:89]
    v_pk_add_f32 v[82:83], v[82:83], v[90:91]
    v_pk_add_f32 v[84:85], v[84:85], v[92:93]
    v_pk_add_f32 v[86:87], v[86:87], v[94:95]
    v_permlane32_swap_b32 v80, v82
    v_permlane32_swap_b32 v81, v83
    v_add_f32 v80, v80, v82
    v_add_f32 v81, v81, v83
    s_nop 1
    v_permlane16_swap_b32 v80, v81
    v_add_f32 v80, v80, v81
    v_permlane32_swap_b32 v84, v86
    v_permlane32_swap_b32 v85, v87
    v_add_f32 v84, v84, v86
    v_add_f32 v85, v85, v87
    s_nop 1
    v_permlane16_swap_b32 v84, v85
    v_add_f32 v84, v84, v85
    v_mov_b32 v64, v80
    v_mov_b32 v65, v84
    s_sleep 7
    s_mov_b32 s91, 400015
    buffer_load_dwordx4 v[240:243], v1, s[40:43], 0 offen offset:0 sc1
    s_mov_b32 s90, 8192
    buffer_load_dwordx4 v[244:247], v1, s[40:43], s90 offen offset:0 sc1
L_pp_28:
    s_waitcnt vmcnt(0)
    v_xor_b32 v240, s85, v240
    v_xor_b32 v241, s86, v241
    v_xor_b32 v242, s87, v242
    v_xor_b32 v243, s88, v243
    v_or3_b32 v31, v240, v241, v242
    v_or_b32 v31, v31, v243
    v_xor_b32 v244, s85, v244
    v_xor_b32 v245, s86, v245
    v_xor_b32 v246, s87, v246
    v_xor_b32 v247, s88, v247
    v_or3_b32 v31, v31, v244, v245
    v_or3_b32 v31, v31, v246, v247
    v_and_b32 v31, 0xff, v31
    v_cmp_ne_u32 vcc, 0, v31
    s_cbranch_vccz L_ppok_30
    s_and_b32 s95, s91, 15
    s_cbranch_scc1 L_y_soon
    v_lshlrev_b32 v56, 4, v0
    ds_read_b128 v[48:51], v56 offset:36864
    ds_read_b128 v[52:55], v56 offset:53248
    s_lshl_b32 s95, s81, 5
    s_add_u32 s95, s95, s98
    s_lshl_b32 s95, s95, 11
    s_add_u32 s95, s95, 2097152
    s_waitcnt lgkmcnt(0)
    buffer_store_dwordx4 v[48:51], v56, s[40:43], s95 offen sc1
    buffer_store_dwordx4 v[52:55], v56, s[40:43], s95 offen offset:1024 sc1
    s_xor_b32 s95, s84, 1
    s_lshl_b32 s95, s95, 22
    v_subrev_u32 v169, s95, v168
    s_mov_b32 s90, 1605632
    buffer_store_dwordx4 v[172:175], v169, s[40:43], s90 offen sc1
    s_cmp_lg_u32 s83, 2
    s_cbranch_scc1 L_noq2_31
    v_lshlrev_b32 v170, 4, v0
    v_lshrrev_b32 v171, 5, v0
    v_mul_u32_u24 v171, 15872, v171
    v_add_u32 v171, v171, v170
    s_lshl_b32 s95, s3, 9
    s_add_u32 s95, s95, 1703936
    ds_read_b128 v[164:167], v170 offset:20480
    s_waitcnt lgkmcnt(0)
    buffer_store_dwordx4 v[164:167], v171, s[40:43], s95 offen sc1
    s_add_u32 s95, s95, 32768
    s_nop 0
    ds_read_b128 v[164:167], v170 offset:21504
    s_waitcnt lgkmcnt(0)
    buffer_store_dwordx4 v[164:167], v171, s[40:43], s95 offen sc1
    s_add_u32 s95, s95, 32768
    s_nop 0
    ds_read_b128 v[164:167], v170 offset:22528
    s_waitcnt lgkmcnt(0)
    buffer_store_dwordx4 v[164:167], v171, s[40:43], s95 offen sc1
    s_add_u32 s95, s95, 32768
    s_nop 0
    ds_read_b128 v[164:167], v170 offset:23552
    s_waitcnt lgkmcnt(0)
    buffer_store_dwordx4 v[164:167], v171, s[40:43], s95 offen sc1
    s_add_u32 s95, s95, 32768
    s_nop 0
L_noq2_31:
L_y_soon:
    buffer_load_dwordx4 v[240:243], v1, s[40:43], 0 offen offset:0 sc1
    s_mov_b32 s90, 8192
    buffer_load_dwordx4 v[244:247], v1, s[40:43], s90 offen offset:0 sc1
    s_sub_u32 s91, s91, 1
    s_cbranch_scc0 L_pp_28
    s_waitcnt vmcnt(0)
L_ppok_30:
    v_pk_add_f32 v[16:17], v[240:241], v[244:245]
    v_pk_add_f32 v[18:19], v[242:243], v[246:247]
L_ppdone_29:
    s_nop 1
    v_permlane32_swap_b32 v16, v18
    v_permlane32_swap_b32 v17, v19
    v_add_f32 v16, v16, v18
    v_add_f32 v17, v17, v19
    s_nop 1
    v_permlane16_swap_b32 v16, v17
    v_add_f32 v16, v16, v17
    v_cvt_pk_bf16_f32 v16, 0, v16
    v_mul_f32 v16, v16, v25
    v_cvt_pk_bf16_f32 v16, 0, v16
    v_add_f32 v16, v16, v24
    v_cvt_pk_bf16_f32 v24, 0, v16
    v_mul_f32 v18, v24, v26
    v_mul_f32 v17, v24, v24
    v_cvt_pk_bf16_f32 v19, 0, v18
    v_mov_b32 v16, v24
    v_sub_f32 v19, v18, v19
    v_cvt_pk_bf16_f32 v18, v18, v19
    ds_write_b16 v5, v18
    ds_write_b16_d16_hi v5, v18 offset:128
    ds_read_b128 v[248:251], v6
    ds_read_b128 v[252:255], v6 offset:64
    ds_write_b32 v3, v24 offset:3584
    v_permlane32_swap_b32 v16, v17
    v_add_f32 v16, v16, v17
    v_mov_b32 v17, v16
    s_nop 1
    v_permlane16_swap_b32 v17, v16
    v_add_f32 v16, v16, v17
    s_waitcnt lgkmcnt(2)
    v_mfma_f32_16x16x32_bf16 v[80:83], v[248:251], v[128:131], 0
    v_mfma_f32_16x16x32_bf16 v[84:87], v[248:251], v[132:135], 0
    v_add_f32_dpp v16, v16, v16 row_ror:8 row_mask:0xf bank_mask:0xf
    v_mfma_f32_16x16x32_bf16 v[88:91], v[248:251], v[136:139], 0
    v_mfma_f32_16x16x32_bf16 v[92:95], v[248:251], v[140:143], 0
    v_add_f32_dpp v16, v16, v16 row_ror:4 row_mask:0xf bank_mask:0xf
    s_waitcnt lgkmcnt(1)
    v_mfma_f32_16x16x32_bf16 v[80:83], v[252:255], v[144:147], v[80:83]
    v_mfma_f32_16x16x32_bf16 v[84:87], v[252:255], v[148:151], v[84:87]
    v_add_f32_dpp v16, v16, v16 row_ror:2 row_mask:0xf bank_mask:0xf
    v_mfma_f32_16x16x32_bf16 v[88:91], v[252:255], v[152:155], v[88:91]
    v_mfma_f32_16x16x32_bf16 v[92:95], v[252:255], v[156:159], v[92:95]
    v_add_f32_dpp v16, v16, v16 row_ror:1 row_mask:0xf bank_mask:0xf
    s_mov_b32 exec_lo, 1
    s_mov_b32 exec_hi, 1
    ds_write_b32 v68, v16 offset:1408
    s_mov_b64 exec, 0xffff
    v_add_f32 v80, v80, v81
    v_add_f32 v84, v84, v85
    v_add_f32 v88, v88, v89
    v_add_f32 v92, v92, v93
    ds_write2_b32 v2, v80, v84 offset0:0 offset1:16
    ds_write2_b32 v2, v88, v92 offset0:32 offset1:48
    s_mov_b64 exec, -1
    s_waitcnt lgkmcnt(0)
    s_barrier
    s_cmp_ge_u32 s101, 28
    s_cbranch_scc1 L_final
    ds_read_b128 v[48:51], v69 offset:1408
    ds_read_b128 v[52:55], v69 offset:1424
    ds_read_b128 v[56:59], v69 offset:1440
    ds_read_b128 v[60:63], v69 offset:1456
    ds_read_b128 v[16:19], v66 offset:28672
    ds_read_b128 v[20:23], v66 offset:29184
    s_waitcnt lgkmcnt(2)
    v_pk_add_f32 v[48:49], v[48:49], v[50:51]
    v_pk_add_f32 v[52:53], v[52:53], v[54:55]
    v_pk_add_f32 v[56:57], v[56:57], v[58:59]
    v_pk_add_f32 v[60:61], v[60:61], v[62:63]
    v_pk_add_f32 v[48:49], v[48:49], v[52:53]
    v_pk_add_f32 v[56:57], v[56:57], v[60:61]
    s_waitcnt lgkmcnt(0)
    v_pk_add_f32 v[16:17], v[16:17], v[20:21]
    v_pk_add_f32 v[18:19], v[18:19], v[22:23]
    v_add_f32 v48, v48, v49
    v_add_f32 v56, v56, v57
    v_permlane32_swap_b32 v16, v18
    v_permlane32_swap_b32 v17, v19
    v_mul_f32 v48, 0x3b000000, v48
    v_mul_f32 v56, 0x3b000000, v56
    v_add_f32 v16, v16, v18
    v_add_f32 v17, v17, v19
    v_fma_f32 v56, -v48, v48, v56
    v_max_f32 v56, 0, v56
    v_permlane16_swap_b32 v16, v17
    v_add_f32 v56, 925353388, v56
    v_rsq_f32 v56, v56
    v_add_f32 v16, v16, v17
    v_fma_f32 v16, -v48, v64, v16
    v_fma_f32 v16, v16, v56, v65
    v_max_f32 v16, 0, v16
    v_cvt_pk_bf16_f32 v16, v16, v16
    ds_write_b16 v5, v16
    ds_read_b128 v[248:251], v6
    ds_read_b128 v[252:255], v6 offset:64
    s_waitcnt lgkmcnt(1)
    v_mfma_f32_16x16x32_bf16 v[80:83], v[248:251], v[208:211], 0
    v_mfma_f32_16x16x32_bf16 v[84:87], v[248:251], v[212:215], 0
    v_mfma_f32_16x16x32_bf16 v[88:91], v[248:251], v[216:219], 0
    v_mfma_f32_16x16x32_bf16 v[92:95], v[248:251], v[220:223], 0
    s_waitcnt lgkmcnt(0)
    v_mfma_f32_16x16x32_bf16 v[80:83], v[252:255], v[224:227], v[80:83]
    v_mfma_f32_16x16x32_bf16 v[84:87], v[252:255], v[228:231], v[84:87]
    v_mfma_f32_16x16x32_bf16 v[88:91], v[252:255], v[232:235], v[88:91]
    v_mfma_f32_16x16x32_bf16 v[92:95], v[252:255], v[236:239], v[92:95]
    s_nop 4
    v_and_or_b32 v16, v80, v7, s85
    v_and_or_b32 v17, v84, v7, s86
    v_and_or_b32 v18, v88, v7, s87
    v_and_or_b32 v19, v92, v7, s88
    s_mov_b64 exec, 0xffff
    buffer_store_dwordx4 v[16:19], v67, s[40:43], 0 offen sc1
    s_mov_b64 exec, -1
L_final:
    s_cmp_lg_u32 s83, 2
    s_cbranch_scc1 L_noq2_32
    s_cmp_lg_u32 s84, 7
    s_cbranch_scc1 L_noq2_32
    v_lshlrev_b32 v170, 4, v0
    v_lshrrev_b32 v171, 5, v0
    v_mul_u32_u24 v171, 15872, v171
    v_add_u32 v171, v171, v170
    s_lshl_b32 s95, s3, 9
    s_add_u32 s95, s95, 1703936
    ds_read_b128 v[164:167], v170 offset:20480
    s_waitcnt lgkmcnt(0)
    buffer_store_dwordx4 v[164:167], v171, s[40:43], s95 offen sc1
    s_add_u32 s95, s95, 32768
    s_nop 0
    ds_read_b128 v[164:167], v170 offset:21504
    s_waitcnt lgkmcnt(0)
    buffer_store_dwordx4 v[164:167], v171, s[40:43], s95 offen sc1
    s_add_u32 s95, s95, 32768
    s_nop 0
    ds_read_b128 v[164:167], v170 offset:22528
    s_waitcnt lgkmcnt(0)
    buffer_store_dwordx4 v[164:167], v171, s[40:43], s95 offen sc1
    s_add_u32 s95, s95, 32768
    s_nop 0
    ds_read_b128 v[164:167], v170 offset:23552
    s_waitcnt lgkmcnt(0)
    buffer_store_dwordx4 v[164:167], v171, s[40:43], s95 offen sc1
    s_add_u32 s95, s95, 32768
    s_nop 0
L_noq2_32:
    s_cmp_eq_u32 s84, 0
    s_cbranch_scc1 L_h3
    s_lshl_b32 s95, s2, 3
    s_add_u32 s95, s95, s84
    s_cmp_lg_u32 s95, 1
    s_cbranch_scc1 L_out
    v_lshlrev_b32 v3, 8, v0
    s_mov_b32 s91, 400015
L_poll_33:
    s_mov_b32 s90, 262144
    buffer_load_dwordx4 v[64:67], v3, s[40:43], s90 offen offset:0 sc1
    s_mov_b32 s90, 294912
    buffer_load_dwordx4 v[68:71], v3, s[40:43], s90 offen offset:0 sc1
    s_mov_b32 s90, 327680
    buffer_load_dwordx4 v[72:75], v3, s[40:43], s90 offen offset:0 sc1
    s_mov_b32 s90, 360448
    buffer_load_dwordx4 v[76:79], v3, s[40:43], s90 offen offset:0 sc1
    s_waitcnt vmcnt(0)
    v_xor_b32 v64, s85, v64
    v_xor_b32 v65, s86, v65
    v_xor_b32 v66, s87, v66
    v_xor_b32 v67, s88, v67
    v_or3_b32 v31, v64, v65, v66
    v_or_b32 v31, v31, v67
    v_xor_b32 v68, s85, v68
    v_xor_b32 v69, s86, v69
    v_xor_b32 v70, s87, v70
    v_xor_b32 v71, s88, v71
    v_or3_b32 v31, v31, v68, v69
    v_or3_b32 v31, v31, v70, v71
    v_xor_b32 v72, s85, v72
    v_xor_b32 v73, s86, v73
    v_xor_b32 v74, s87, v74
    v_xor_b32 v75, s88, v75
    v_or3_b32 v31, v31, v72, v73
    v_or3_b32 v31, v31, v74, v75
    v_xor_b32 v76, s85, v76
    v_xor_b32 v77, s86, v77
    v_xor_b32 v78, s87, v78
    v_xor_b32 v79, s88, v79
    v_or3_b32 v31, v31, v76, v77
    v_or3_b32 v31, v31, v78, v79
    v_and_b32 v31, 0xff, v31
    v_cmp_ne_u32 vcc, 0, v31
    s_cbranch_vccz L_done_34
    s_sub_u32 s91, s91, 1
    s_cbranch_scc0 L_poll_33
L_done_34:
    v_mov_b32 v3, 0
    v_mov_b32 v4, s99
    s_mov_b64 exec, 1
    buffer_store_dword v4, v3, s[40:43], 0 offen offset:0 sc1
    s_branch L_out
L_h3:
    s_cmp_lt_u32 s101, 28
    s_cbranch_scc1 L_h3_go
    s_sleep 12
L_h3_go:
    s_mul_i32 s95, s81, 57344
    s_lshl_b32 s96, s98, 6
    s_add_u32 s95, s95, s96
    s_add_u32 s95, s95, 1048576
    v_and_b32 v31, 3, v0
    v_lshrrev_b32 v3, 2, v0
    v_lshlrev_b32 v3, 11, v3
    v_lshl_add_u32 v3, v31, 4, v3
    v_add_u32 v3, s95, v3
    v_cmp_gt_u32 vcc, 48, v0
    v_mov_b32 v4, 0x8000
    s_nop 0
    v_cndmask_b32 v4, 0, v4, vcc
    v_cndmask_b32 v29, 0, 1.0, vcc
    v_add_u32 v4, v4, v3
    v_lshrrev_b32 v2, 4, v0
    v_lshl_add_u32 v2, v31, 2, v2
    s_lshl_b32 s96, s98, 4
    v_add_u32 v2, s96, v2
    v_lshlrev_b32 v1, 2, v2
    ds_read_b32 v24, v1 offset:3584
    s_lshl_b32 s96, s81, 10
    v_lshlrev_b32 v2, 1, v2
    v_add_u32 v2, s96, v2
    s_sleep 12
    s_mov_b32 s91, 400015
    buffer_load_dwordx4 v[240:243], v3, s[40:43], 0 offen offset:0 sc1
    buffer_load_dwordx4 v[244:247], v4, s[40:43], 0 offen offset:0 sc1
L_pp_35:
    s_waitcnt vmcnt(0)
    v_xor_b32 v240, s85, v240
    v_xor_b32 v241, s86, v241
    v_xor_b32 v242, s87, v242
    v_xor_b32 v243, s88, v243
    v_or3_b32 v31, v240, v241, v242
    v_or_b32 v31, v31, v243
    v_xor_b32 v244, s85, v244
    v_xor_b32 v245, s86, v245
    v_xor_b32 v246, s87, v246
    v_xor_b32 v247, s88, v247
    v_or3_b32 v31, v31, v244, v245
    v_or3_b32 v31, v31, v246, v247
    v_and_b32 v31, 0xff, v31
    v_cmp_ne_u32 vcc, 0, v31
    s_cbranch_vccz L_ppok_37
    buffer_load_dwordx4 v[240:243], v3, s[40:43], 0 offen offset:0 sc1
    buffer_load_dwordx4 v[244:247], v4, s[40:43], 0 offen offset:0 sc1
    s_sub_u32 s91, s91, 1
    s_cbranch_scc0 L_pp_35
    s_waitcnt vmcnt(0)
L_ppok_37:
    v_fma_f32 v64, v244, v29, v240
    v_fma_f32 v65, v245, v29, v241
    v_fma_f32 v66, v246, v29, v242
    v_fma_f32 v67, v247, v29, v243
L_ppdone_36:
    s_nop 0
    v_permlane32_swap_b32 v64, v66
    v_permlane32_swap_b32 v65, v67
    v_add_f32 v64, v64, v66
    v_add_f32 v65, v65, v67
    s_nop 1
    v_permlane16_swap_b32 v64, v65
    v_add_f32 v64, v64, v65
    s_nop 1
    v_add_f32_dpp v64, v64, v64 row_ror:4 row_mask:0xf bank_mask:0xf
    s_nop 1
    v_add_f32_dpp v64, v64, v64 row_ror:8 row_mask:0xf bank_mask:0xf
    v_cvt_pk_bf16_f32 v64, 0, v64
    v_mul_f32 v64, v64, v28
    v_cvt_pk_bf16_f32 v64, 0, v64
    s_waitcnt lgkmcnt(0)
    v_add_f32 v64, v64, v24
    v_cvt_pk_bf16_f32 v64, v64, v64
    s_mov_b32 exec_lo, 0x000f000f
    s_mov_b32 exec_hi, 0x000f000f
    buffer_store_short v64, v2, s[68:71], 0 offen
L_out:
L_end:
    s_endpgm
.section .rodata,"a"
.p2align 6
.amdhsa_kernel adaLN_cond__gqa_block_cached__dense_activation_relu__decode_kernel
  .amdhsa_next_free_vgpr 256
  .amdhsa_next_free_sgpr 102
  .amdhsa_accum_offset 256
  .amdhsa_group_segment_fixed_size 0
  .amdhsa_kernarg_size 104
  .amdhsa_user_sgpr_count 2
  .amdhsa_user_sgpr_kernarg_segment_ptr 1
  .amdhsa_system_sgpr_workgroup_id_x 1
  .amdhsa_float_denorm_mode_32 3
.end_amdhsa_kernel
```
